```python
import torch

def _softmax(x, axis=-1):
    return torch.softmax(x, dim=axis)

def _gelu(x):
    return torch.nn.functional.gelu(x, approximate='tanh')

def _silu(x):
    return torch.nn.functional.silu(x)

def _sigmoid(x):
    return torch.sigmoid(x)

def _layernorm(x, axis=-1, eps=1e-05):
    m = x.mean(dim=axis, keepdim=True)
    v = x.var(dim=axis, keepdim=True, unbiased=False)
    return (x - m) / torch.sqrt(v + eps)

def _scatter_add(tgt, idx, src, axis=0):
    return tgt.clone().index_add_(axis, idx, src)

def _segment_sum(src, seg, n):
    out = torch.zeros((n,) + src.shape[1:], dtype=src.dtype)
    return out.index_add_(0, seg, src)

def _pad(x, pw):
    flat = tuple((v for pair in reversed(pw) for v in pair))
    return torch.nn.functional.pad(x, flat)
kernel_name = 'adaLN_cond__ssm_conv_s4d__glu_gated_geglu__prompt'

def setup_inputs():

    _w = lambda a: (lambda t: t.to(torch.bfloat16) if t.is_floating_point() else t)(torch.as_tensor(a))

    def _A_setup():
        Bsz, L, D, N = (1, 2048, 512, 128)
        return {'u': _w((lambda *s: torch.randn(*s, dtype=torch.bfloat16) * 0.05)(Bsz, L, D)), 'log_A_real': _w((lambda *s: torch.randn(*s, dtype=torch.bfloat16) * 3.2)(D, N) * 0.5), 'A_imag': _w((lambda *s: torch.randn(*s, dtype=torch.bfloat16) * 0.1)(D, N) * 3.14), 'C_real': _w((lambda *s: torch.randn(*s, dtype=torch.bfloat16) * 0.2)(D, N) / N ** 0.5), 'C_imag': _w((lambda *s: torch.randn(*s, dtype=torch.bfloat16) * 0.2)(D, N) / N ** 0.5), 'log_dt': _w((lambda *s: torch.randn(*s, dtype=torch.bfloat16) * 0.1)(D) * 0.5 - 4.0), 'D_skip': _w((lambda *s: torch.randn(*s, dtype=torch.bfloat16) * 0.1)(D))}
    _A_in = _A_setup()

    def _B_setup():
        B, S, Dm, Df = (1, 2048, 512, 1792)
        return {'x': _w((lambda *s: torch.randn(*s, dtype=torch.bfloat16) * 0.05)(B, S, Dm)), 'w_gate': _w((lambda *s: torch.randn(*s, dtype=torch.bfloat16) * 1.6)(Dm, Df) * Dm ** (-0.5)), 'w_up': _w((lambda *s: torch.randn(*s, dtype=torch.bfloat16) * 1.6)(Dm, Df) * Dm ** (-0.5)), 'w_down': _w((lambda *s: torch.randn(*s, dtype=torch.bfloat16) * 1.6)(Df, Dm) * Df ** (-0.5))}
    _B_in = _B_setup()
    return {'A_u': _A_in['u'], 'A_log_A_real': _A_in['log_A_real'], 'A_A_imag': _A_in['A_imag'], 'A_C_real': _A_in['C_real'], 'A_C_imag': _A_in['C_imag'], 'A_log_dt': _A_in['log_dt'], 'A_D_skip': _A_in['D_skip'], 'B_x': _B_in['x'], 'B_w_gate': _B_in['w_gate'], 'B_w_up': _B_in['w_up'], 'B_w_down': _B_in['w_down'], 'c': _w((lambda *s: torch.randn(*s, dtype=torch.bfloat16) * 0.2)(1, 512) * 8.0), 'w_mod': _w((lambda *s: torch.randn(*s, dtype=torch.bfloat16) * 0.2)(512, 6 * 512) * 512 ** (-0.5) * 8.0)}

def reference(A_u, A_log_A_real, A_A_imag, A_C_real, A_C_imag, A_log_dt, A_D_skip, B_x, B_w_gate, B_w_up, B_w_down, c, w_mod):

    def _A_ref(u, log_A_real, A_imag, C_real, C_imag, log_dt, D_skip):
        L = u.shape[1]
        dt = torch.exp(log_dt)
        A = -torch.exp(log_A_real) + 1j * A_imag
        C = (C_real + 1j * C_imag) * dt[:, None]
        pos = (lambda x, dt: x.to(dt))(torch.arange(L), log_dt.dtype)
        P = torch.exp((A * dt[:, None])[:, :, None] * pos[None, None, :])
        K = 2.0 * torch.einsum('dn,dnl->dl', C, P).real
        L2 = 2 * L
        u_t = (lambda x, *d: x.permute(*d))(u, 0, 2, 1)
        Kf = (lambda x, *a, **k: torch.fft.rfft(x.float(), *a, **k))(K, L2)
        Uf = (lambda x, *a, **k: torch.fft.rfft(x.float(), *a, **k))(u_t, L2)
        y = (lambda x, *a, **k: torch.fft.irfft(x, *a, **k).to(torch.bfloat16))(Uf * Kf[None, :, :], L2)[:, :, :L]
        y = (lambda x, *d: x.permute(*d))(y, 0, 2, 1)
        return y + u * D_skip[None, None, :]

    def _B_ref(x, w_gate, w_up, w_down):
        g = torch.einsum('bsd,df->bsf', x, w_gate)
        u = torch.einsum('bsd,df->bsf', x, w_up)
        h = _gelu(g) * u
        return torch.einsum('bsf,fd->bsd', h, w_down)
    x = A_u
    mod = (_silu(c) @ w_mod).reshape(c.shape[0], 6, 1, -1)
    sa, ca, ga, sb, cb, gb = (mod[:, 0].clone(), mod[:, 1].clone(), mod[:, 2].clone(), mod[:, 3].clone(), mod[:, 4].clone(), mod[:, 5].clone())
    h = _layernorm(x, axis=-1) * (1 + ca) + sa
    x = x + ga * _A_ref(h, A_log_A_real, A_A_imag, A_C_real, A_C_imag, A_log_dt, A_D_skip)
    h = _layernorm(x, axis=-1) * (1 + cb) + sb
    x = x + gb * _B_ref(h, B_w_gate, B_w_up, B_w_down)
    return x
```

```asm
; @launch grid=(256,1,1) block=(512,1,1) lds=163840
.amdgcn_target "amdgcn-amd-amdhsa--gfx950"
.text
.globl adaLN_cond__ssm_conv_s4d__glu_gated_geglu__prompt_kernel
.p2align 8
.type adaLN_cond__ssm_conv_s4d__glu_gated_geglu__prompt_kernel,@function
adaLN_cond__ssm_conv_s4d__glu_gated_geglu__prompt_kernel:
    s_load_dwordx16 s[16:31], s[0:1], 0
    s_load_dwordx16 s[32:47], s[0:1], 64
    s_cmp_ge_u32 s2, 256
    s_cbranch_scc1 K_END
    v_lshrrev_b32 v1, 6, v0
    s_nop 0
    v_readfirstlane_b32 s3, v1
    v_and_b32 v0, 63, v0
    s_and_b32 s4, s2, 7
    s_lshl_b32 s4, s4, 5
    s_lshr_b32 s5, s2, 3
    s_add_u32 s97, s4, s5
    v_lshlrev_b32 v1, 2, v0
    v_add_u32 v1, 163584, v1
    v_mov_b32 v2, 0
    ds_write_b32 v1, v2
    s_waitcnt lgkmcnt(0)
    s_load_dword s96, s[46:47], 126976
    s_cmp_eq_u32 s3, 7
    s_cbranch_scc0 NOPF
    s_cmp_ge_u32 s2, 64
    s_cbranch_scc1 NOPF
    s_getpc_b64 s[4:5]
PFBASE:
    s_lshr_b32 s6, s2, 3
    s_lshl_b32 s6, s6, 12
    v_lshlrev_b32 v1, 4, v0
    v_add_u32 v1, s6, v1
    global_load_dwordx4 v[200:203], v1, s[4:5] offset:0
    global_load_dwordx4 v[204:207], v1, s[4:5] offset:1024
    global_load_dwordx4 v[208:211], v1, s[4:5] offset:2048
    global_load_dwordx4 v[212:215], v1, s[4:5] offset:3072
NOPF:
    s_cmp_ge_u32 s3, 4
    s_cbranch_scc1 AUX
    s_lshr_b32 s5, s3, 1
    s_lshl_b32 s6, s97, 1
    s_add_u32 s6, s6, s5
    s_and_b32 s7, s3, 1
    s_lshl_b32 s8, s6, 8
    s_lshl_b32 s9, s7, 7
    s_add_u32 s8, s8, s9
    v_lshlrev_b32 v1, 1, v0
    v_add_u32 v1, s8, v1
    s_lshl_b32 s9, s6, 1
    v_mov_b32 v2, s9
    s_lshl_b32 s9, s3, 6
    v_add_u32 v240, s9, v0
    s_lshl_b32 s9, s97, 2
    global_load_ushort v7, v2, s[26:27]
    global_load_ushort v3, v1, s[18:19]
    global_load_ushort v4, v1, s[20:21]
    global_load_ushort v5, v1, s[22:23]
    global_load_ushort v6, v1, s[24:25]
    s_add_u32 s50, s28, s9
    s_addc_u32 s51, s29, 0
    s_load_dword s99, s[50:51], 0
    s_barrier
    s_mul_i32 s10, s3, 14416
    v_lshlrev_b32 v8, 2, v0
    v_add_u32 v8, s10, v8
    v_and_b32 v9, 31, v0
    v_mul_u32_u24 v9, 272, v9
    v_lshrrev_b32 v10, 5, v0
    v_lshlrev_b32 v11, 4, v10
    v_add3_u32 v9, v9, v11, s10
    s_waitcnt vmcnt(3)
    v_lshlrev_b32 v7, 16, v7
    v_lshlrev_b32 v3, 16, v3
    v_mul_f32 v7, 0x3fb8aa3b, v7
    v_mul_f32 v3, 0x3fb8aa3b, v3
    v_exp_f32 v7, v7
    v_exp_f32 v3, v3
    v_cvt_pk_bf16_f32 v7, v7, v7
    v_lshlrev_b32 v7, 16, v7
    v_cvt_pk_bf16_f32 v3, v3, v3
    v_lshlrev_b32 v3, 16, v3
    v_mul_f32 v3, v3, v7
    v_mul_f32 v3, 0xbfb8aa3b, v3
    s_waitcnt vmcnt(0)
    v_lshlrev_b32 v4, 16, v4
    v_lshlrev_b32 v5, 16, v5
    v_lshlrev_b32 v6, 16, v6
    v_mul_f32 v4, v4, v7
    v_mul_f32 v4, 0.15915494, v4
    v_mul_f32 v12, v5, v7
    v_mul_f32 v13, v6, v7
    v_max_f32 v14, abs(v12), abs(v13)
    v_mul_f32 v24, 0x3f800000, v3
    v_mul_f32 v25, 0x3f800000, v4
    v_exp_f32 v24, v24
    v_fract_f32 v25, v25
    v_cos_f32 v16, v25
    v_sin_f32 v17, v25
    v_mul_f32 v16, v16, v24
    v_mul_f32 v17, v17, v24
    v_mul_f32 v24, 0x41000000, v3
    v_mul_f32 v25, 0x41000000, v4
    v_exp_f32 v24, v24
    v_fract_f32 v25, v25
    v_cos_f32 v18, v25
    v_sin_f32 v19, v25
    v_mul_f32 v18, v18, v24
    v_mul_f32 v19, v19, v24
    v_mul_f32 v24, 0x42800000, v3
    v_mul_f32 v25, 0x42800000, v4
    v_exp_f32 v24, v24
    v_fract_f32 v25, v25
    v_cos_f32 v20, v25
    v_sin_f32 v21, v25
    v_mul_f32 v20, v20, v24
    v_mul_f32 v21, v21, v24
    v_mul_f32 v24, 0x43800000, v3
    v_mul_f32 v25, 0x43800000, v4
    v_exp_f32 v24, v24
    v_fract_f32 v25, v25
    v_cos_f32 v22, v25
    v_sin_f32 v23, v25
    v_mul_f32 v22, v22, v24
    v_mul_f32 v23, v23, v24
    v_max_f32 v14, v14, v14 row_shr:1 bound_ctrl:0
    s_nop 1
    v_max_f32 v14, v14, v14 row_shr:2 bound_ctrl:0
    s_nop 1
    v_max_f32 v14, v14, v14 row_shr:4 bound_ctrl:0
    s_nop 1
    v_max_f32 v14, v14, v14 row_shr:8 bound_ctrl:0
    s_nop 1
    v_max_f32 v14, v14, v14 row_bcast:15 row_mask:0xa
    s_nop 1
    v_max_f32 v14, v14, v14 row_bcast:31 row_mask:0xc
    s_nop 0
    v_readlane_b32 s11, v14, 63
    s_nop 1
    s_lshr_b32 s11, s11, 23
    s_max_u32 s11, s11, 32
    s_min_u32 s11, s11, 250
    s_sub_u32 s12, 268, s11
    s_lshl_b32 s12, s12, 23
    s_sub_u32 s13, s11, 28
    s_lshl_b32 s13, s13, 23
    v_mul_f32 v12, s12, v12
    v_mul_f32 v13, s12, v13
    v_pk_mul_f32 v[24:25], v[16:17], v[16:17] op_sel_hi:[0,1]
    v_fma_f32 v26, -v17, v17, v24
    v_fma_f32 v27, v17, v16, v25
    v_pk_mul_f32 v[34:35], v[20:21], v[20:21] op_sel_hi:[0,1]
    v_fma_f32 v30, -v21, v21, v34
    v_fma_f32 v31, v21, v20, v35
    v_pk_mul_f32 v[24:25], v[26:27], v[26:27] op_sel_hi:[0,1]
    v_fma_f32 v28, -v27, v27, v24
    v_fma_f32 v29, v27, v26, v25
    v_pk_mul_f32 v[34:35], v[30:31], v[20:21] op_sel_hi:[0,1]
    v_fma_f32 v32, -v31, v21, v34
    v_fma_f32 v33, v31, v20, v35
    v_mov_b32 v40, 0x47000000
    v_mov_b32 v41, 0
    v_cvt_pk_f16_f32 v100, v40, -v41
    ds_write_b32 v8, v100 offset:5712
    v_cvt_pk_f16_f32 v101, v12, v13
    ds_write_b32 v8, v101 offset:0
    v_pk_mul_f32 v[24:25], v[40:41], v[18:19] op_sel_hi:[0,1]
    v_fma_f32 v42, -v41, v19, v24
    v_fma_f32 v43, v41, v18, v25
    v_pk_mul_f32 v[34:35], v[12:13], v[16:17] op_sel_hi:[0,1]
    v_fma_f32 v56, -v13, v17, v34
    v_fma_f32 v57, v13, v16, v35
    v_pk_mul_f32 v[36:37], v[12:13], v[22:23] op_sel_hi:[0,1]
    v_fma_f32 v60, -v13, v23, v36
    v_fma_f32 v61, v13, v22, v37
    v_cvt_pk_f16_f32 v102, v42, -v43
    ds_write_b32 v8, v102 offset:5984
    v_cvt_pk_f16_f32 v103, v56, v57
    ds_write_b32 v8, v103 offset:272
    v_pk_mul_f32 v[24:25], v[42:43], v[18:19] op_sel_hi:[0,1]
    v_fma_f32 v44, -v43, v19, v24
    v_fma_f32 v45, v43, v18, v25
    v_pk_mul_f32 v[34:35], v[56:57], v[16:17] op_sel_hi:[0,1]
    v_fma_f32 v58, -v57, v17, v34
    v_fma_f32 v59, v57, v16, v35
    v_pk_mul_f32 v[36:37], v[60:61], v[22:23] op_sel_hi:[0,1]
    v_fma_f32 v62, -v61, v23, v36
    v_fma_f32 v63, v61, v22, v37
    v_cvt_pk_f16_f32 v104, v44, -v45
    ds_write_b32 v8, v104 offset:6256
    v_cvt_pk_f16_f32 v105, v58, v59
    ds_write_b32 v8, v105 offset:544
    v_pk_mul_f32 v[24:25], v[44:45], v[18:19] op_sel_hi:[0,1]
    v_fma_f32 v46, -v45, v19, v24
    v_fma_f32 v47, v45, v18, v25
    v_pk_mul_f32 v[34:35], v[58:59], v[16:17] op_sel_hi:[0,1]
    v_fma_f32 v56, -v59, v17, v34
    v_fma_f32 v57, v59, v16, v35
    v_pk_mul_f32 v[36:37], v[62:63], v[22:23] op_sel_hi:[0,1]
    v_fma_f32 v64, -v63, v23, v36
    v_fma_f32 v65, v63, v22, v37
    v_cvt_pk_f16_f32 v106, v46, -v47
    ds_write_b32 v8, v106 offset:6528
    v_cvt_pk_f16_f32 v107, v56, v57
    ds_write_b32 v8, v107 offset:816
    v_pk_mul_f32 v[24:25], v[46:47], v[18:19] op_sel_hi:[0,1]
    v_fma_f32 v48, -v47, v19, v24
    v_fma_f32 v49, v47, v18, v25
    v_pk_mul_f32 v[34:35], v[56:57], v[16:17] op_sel_hi:[0,1]
    v_fma_f32 v58, -v57, v17, v34
    v_fma_f32 v59, v57, v16, v35
    v_pk_mul_f32 v[36:37], v[64:65], v[22:23] op_sel_hi:[0,1]
    v_fma_f32 v66, -v65, v23, v36
    v_fma_f32 v67, v65, v22, v37
    v_cvt_pk_f16_f32 v100, v48, -v49
    ds_write_b32 v8, v100 offset:6800
    v_cvt_pk_f16_f32 v101, v58, v59
    ds_write_b32 v8, v101 offset:1088
    v_pk_mul_f32 v[24:25], v[48:49], v[18:19] op_sel_hi:[0,1]
    v_fma_f32 v50, -v49, v19, v24
    v_fma_f32 v51, v49, v18, v25
    v_pk_mul_f32 v[34:35], v[58:59], v[16:17] op_sel_hi:[0,1]
    v_fma_f32 v56, -v59, v17, v34
    v_fma_f32 v57, v59, v16, v35
    v_pk_mul_f32 v[36:37], v[66:67], v[22:23] op_sel_hi:[0,1]
    v_fma_f32 v68, -v67, v23, v36
    v_fma_f32 v69, v67, v22, v37
    v_cvt_pk_f16_f32 v102, v50, -v51
    ds_write_b32 v8, v102 offset:7072
    v_cvt_pk_f16_f32 v103, v56, v57
    ds_write_b32 v8, v103 offset:1360
    v_pk_mul_f32 v[24:25], v[50:51], v[18:19] op_sel_hi:[0,1]
    v_fma_f32 v52, -v51, v19, v24
    v_fma_f32 v53, v51, v18, v25
    v_pk_mul_f32 v[34:35], v[56:57], v[16:17] op_sel_hi:[0,1]
    v_fma_f32 v58, -v57, v17, v34
    v_fma_f32 v59, v57, v16, v35
    v_pk_mul_f32 v[36:37], v[68:69], v[22:23] op_sel_hi:[0,1]
    v_fma_f32 v70, -v69, v23, v36
    v_fma_f32 v71, v69, v22, v37
    v_cvt_pk_f16_f32 v104, v52, -v53
    ds_write_b32 v8, v104 offset:7344
    v_cvt_pk_f16_f32 v105, v58, v59
    ds_write_b32 v8, v105 offset:1632
    v_pk_mul_f32 v[24:25], v[52:53], v[18:19] op_sel_hi:[0,1]
    v_fma_f32 v54, -v53, v19, v24
    v_fma_f32 v55, v53, v18, v25
    v_pk_mul_f32 v[34:35], v[58:59], v[16:17] op_sel_hi:[0,1]
    v_fma_f32 v56, -v59, v17, v34
    v_fma_f32 v57, v59, v16, v35
    v_pk_mul_f32 v[36:37], v[70:71], v[22:23] op_sel_hi:[0,1]
    v_fma_f32 v72, -v71, v23, v36
    v_fma_f32 v73, v71, v22, v37
    v_cvt_pk_f16_f32 v106, v54, -v55
    ds_write_b32 v8, v106 offset:7616
    v_cvt_pk_f16_f32 v107, v56, v57
    ds_write_b32 v8, v107 offset:1904
    v_pk_mul_f32 v[36:37], v[72:73], v[22:23] op_sel_hi:[0,1]
    v_fma_f32 v74, -v73, v23, v36
    v_fma_f32 v75, v73, v22, v37
    v_cvt_pk_f16_f32 v100, v60, v61
    ds_write_b32 v8, v100 offset:2176
    v_cvt_pk_f16_f32 v101, v62, v63
    ds_write_b32 v8, v101 offset:3264
    v_cvt_pk_f16_f32 v102, v64, v65
    ds_write_b32 v8, v102 offset:3808
    v_cvt_pk_f16_f32 v103, v66, v67
    ds_write_b32 v8, v103 offset:4352
    v_cvt_pk_f16_f32 v104, v68, v69
    ds_write_b32 v8, v104 offset:4624
    v_cvt_pk_f16_f32 v105, v70, v71
    ds_write_b32 v8, v105 offset:4896
    v_cvt_pk_f16_f32 v106, v72, v73
    ds_write_b32 v8, v106 offset:5168
    v_cvt_pk_f16_f32 v107, v74, v75
    ds_write_b32 v8, v107 offset:5440
    v_pk_mul_f32 v[24:25], v[60:61], v[26:27] op_sel_hi:[0,1]
    v_fma_f32 v76, -v61, v27, v24
    v_fma_f32 v77, v61, v26, v25
    v_pk_mul_f32 v[34:35], v[62:63], v[28:29] op_sel_hi:[0,1]
    v_fma_f32 v78, -v63, v29, v34
    v_fma_f32 v79, v63, v28, v35
    v_pk_mul_f32 v[36:37], v[64:65], v[28:29] op_sel_hi:[0,1]
    v_fma_f32 v80, -v65, v29, v36
    v_fma_f32 v81, v65, v28, v37
    v_cvt_pk_f16_f32 v100, v76, v77
    ds_write_b32 v8, v100 offset:2448
    v_cvt_pk_f16_f32 v101, v78, v79
    ds_write_b32 v8, v101 offset:3536
    v_cvt_pk_f16_f32 v102, v80, v81
    ds_write_b32 v8, v102 offset:4080
    v_pk_mul_f32 v[24:25], v[76:77], v[26:27] op_sel_hi:[0,1]
    v_fma_f32 v82, -v77, v27, v24
    v_fma_f32 v83, v77, v26, v25
    v_cvt_pk_f16_f32 v103, v82, v83
    ds_write_b32 v8, v103 offset:2720
    v_pk_mul_f32 v[24:25], v[82:83], v[26:27] op_sel_hi:[0,1]
    v_fma_f32 v84, -v83, v27, v24
    v_fma_f32 v85, v83, v26, v25
    v_cvt_pk_f16_f32 v104, v84, v85
    ds_write_b32 v8, v104 offset:2992
    v_pk_mul_f32 v[24:25], v[40:41], v[20:21] op_sel_hi:[0,1]
    v_fma_f32 v86, -v41, v21, v24
    v_fma_f32 v87, v41, v20, v25
    v_cvt_pk_f16_f32 v105, v86, -v87
    ds_write_b32 v8, v105 offset:7888
    v_pk_mul_f32 v[34:35], v[42:43], v[20:21] op_sel_hi:[0,1]
    v_fma_f32 v88, -v43, v21, v34
    v_fma_f32 v89, v43, v20, v35
    v_cvt_pk_f16_f32 v106, v88, -v89
    ds_write_b32 v8, v106 offset:8160
    v_pk_mul_f32 v[36:37], v[44:45], v[20:21] op_sel_hi:[0,1]
    v_fma_f32 v90, -v45, v21, v36
    v_fma_f32 v91, v45, v20, v37
    v_cvt_pk_f16_f32 v107, v90, -v91
    ds_write_b32 v8, v107 offset:8432
    v_pk_mul_f32 v[38:39], v[46:47], v[20:21] op_sel_hi:[0,1]
    v_fma_f32 v92, -v47, v21, v38
    v_fma_f32 v93, v47, v20, v39
    v_cvt_pk_f16_f32 v100, v92, -v93
    ds_write_b32 v8, v100 offset:8704
    v_pk_mul_f32 v[24:25], v[48:49], v[20:21] op_sel_hi:[0,1]
    v_fma_f32 v86, -v49, v21, v24
    v_fma_f32 v87, v49, v20, v25
    v_cvt_pk_f16_f32 v101, v86, -v87
    ds_write_b32 v8, v101 offset:8976
    v_pk_mul_f32 v[34:35], v[50:51], v[20:21] op_sel_hi:[0,1]
    v_fma_f32 v88, -v51, v21, v34
    v_fma_f32 v89, v51, v20, v35
    v_cvt_pk_f16_f32 v102, v88, -v89
    ds_write_b32 v8, v102 offset:9248
    v_pk_mul_f32 v[36:37], v[52:53], v[20:21] op_sel_hi:[0,1]
    v_fma_f32 v90, -v53, v21, v36
    v_fma_f32 v91, v53, v20, v37
    v_cvt_pk_f16_f32 v103, v90, -v91
    ds_write_b32 v8, v103 offset:9520
    v_pk_mul_f32 v[38:39], v[54:55], v[20:21] op_sel_hi:[0,1]
    v_fma_f32 v92, -v55, v21, v38
    v_fma_f32 v93, v55, v20, v39
    v_cvt_pk_f16_f32 v104, v92, -v93
    ds_write_b32 v8, v104 offset:9792
    v_pk_mul_f32 v[24:25], v[40:41], v[30:31] op_sel_hi:[0,1]
    v_fma_f32 v86, -v41, v31, v24
    v_fma_f32 v87, v41, v30, v25
    v_cvt_pk_f16_f32 v105, v86, -v87
    ds_write_b32 v8, v105 offset:10064
    v_pk_mul_f32 v[34:35], v[42:43], v[30:31] op_sel_hi:[0,1]
    v_fma_f32 v88, -v43, v31, v34
    v_fma_f32 v89, v43, v30, v35
    v_cvt_pk_f16_f32 v106, v88, -v89
    ds_write_b32 v8, v106 offset:10336
    v_pk_mul_f32 v[36:37], v[44:45], v[30:31] op_sel_hi:[0,1]
    v_fma_f32 v90, -v45, v31, v36
    v_fma_f32 v91, v45, v30, v37
    v_cvt_pk_f16_f32 v107, v90, -v91
    ds_write_b32 v8, v107 offset:10608
    v_pk_mul_f32 v[38:39], v[46:47], v[30:31] op_sel_hi:[0,1]
    v_fma_f32 v92, -v47, v31, v38
    v_fma_f32 v93, v47, v30, v39
    v_cvt_pk_f16_f32 v100, v92, -v93
    ds_write_b32 v8, v100 offset:10880
    v_pk_mul_f32 v[24:25], v[48:49], v[30:31] op_sel_hi:[0,1]
    v_fma_f32 v86, -v49, v31, v24
    v_fma_f32 v87, v49, v30, v25
    v_cvt_pk_f16_f32 v101, v86, -v87
    ds_write_b32 v8, v101 offset:11152
    v_pk_mul_f32 v[34:35], v[50:51], v[30:31] op_sel_hi:[0,1]
    v_fma_f32 v88, -v51, v31, v34
    v_fma_f32 v89, v51, v30, v35
    v_cvt_pk_f16_f32 v102, v88, -v89
    ds_write_b32 v8, v102 offset:11424
    v_pk_mul_f32 v[36:37], v[52:53], v[30:31] op_sel_hi:[0,1]
    v_fma_f32 v90, -v53, v31, v36
    v_fma_f32 v91, v53, v30, v37
    v_cvt_pk_f16_f32 v103, v90, -v91
    ds_write_b32 v8, v103 offset:11696
    v_pk_mul_f32 v[38:39], v[54:55], v[30:31] op_sel_hi:[0,1]
    v_fma_f32 v92, -v55, v31, v38
    v_fma_f32 v93, v55, v30, v39
    v_cvt_pk_f16_f32 v104, v92, -v93
    ds_write_b32 v8, v104 offset:11968
    v_pk_mul_f32 v[24:25], v[40:41], v[32:33] op_sel_hi:[0,1]
    v_fma_f32 v86, -v41, v33, v24
    v_fma_f32 v87, v41, v32, v25
    v_cvt_pk_f16_f32 v105, v86, -v87
    ds_write_b32 v8, v105 offset:12240
    v_pk_mul_f32 v[34:35], v[42:43], v[32:33] op_sel_hi:[0,1]
    v_fma_f32 v88, -v43, v33, v34
    v_fma_f32 v89, v43, v32, v35
    v_cvt_pk_f16_f32 v106, v88, -v89
    ds_write_b32 v8, v106 offset:12512
    v_pk_mul_f32 v[36:37], v[44:45], v[32:33] op_sel_hi:[0,1]
    v_fma_f32 v90, -v45, v33, v36
    v_fma_f32 v91, v45, v32, v37
    v_cvt_pk_f16_f32 v107, v90, -v91
    ds_write_b32 v8, v107 offset:12784
    v_pk_mul_f32 v[38:39], v[46:47], v[32:33] op_sel_hi:[0,1]
    v_fma_f32 v92, -v47, v33, v38
    v_fma_f32 v93, v47, v32, v39
    v_cvt_pk_f16_f32 v100, v92, -v93
    ds_write_b32 v8, v100 offset:13056
    v_pk_mul_f32 v[24:25], v[48:49], v[32:33] op_sel_hi:[0,1]
    v_fma_f32 v86, -v49, v33, v24
    v_fma_f32 v87, v49, v32, v25
    v_cvt_pk_f16_f32 v101, v86, -v87
    ds_write_b32 v8, v101 offset:13328
    v_pk_mul_f32 v[34:35], v[50:51], v[32:33] op_sel_hi:[0,1]
    v_fma_f32 v88, -v51, v33, v34
    v_fma_f32 v89, v51, v32, v35
    v_cvt_pk_f16_f32 v102, v88, -v89
    ds_write_b32 v8, v102 offset:13600
    v_pk_mul_f32 v[36:37], v[52:53], v[32:33] op_sel_hi:[0,1]
    v_fma_f32 v90, -v53, v33, v36
    v_fma_f32 v91, v53, v32, v37
    v_cvt_pk_f16_f32 v103, v90, -v91
    ds_write_b32 v8, v103 offset:13872
    v_pk_mul_f32 v[38:39], v[54:55], v[32:33] op_sel_hi:[0,1]
    v_fma_f32 v92, -v55, v33, v38
    v_fma_f32 v93, v55, v32, v39
    v_cvt_pk_f16_f32 v104, v92, -v93
    ds_write_b32 v8, v104 offset:14144
    s_waitcnt lgkmcnt(0)
    s_add_u32 s96, s96, 1
    ds_read_b128 v[40:43], v9 offset:0
    ds_read_b128 v[44:47], v9 offset:5712
    ds_read_b128 v[48:51], v9 offset:32
    ds_read_b128 v[52:55], v9 offset:5744
    ds_read_b128 v[56:59], v9 offset:64
    ds_read_b128 v[60:63], v9 offset:5776
    ds_read_b128 v[64:67], v9 offset:96
    ds_read_b128 v[68:71], v9 offset:5808
    ds_read_b128 v[72:75], v9 offset:128
    ds_read_b128 v[76:79], v9 offset:5840
    ds_read_b128 v[80:83], v9 offset:160
    ds_read_b128 v[84:87], v9 offset:5872
    ds_read_b128 v[88:91], v9 offset:192
    ds_read_b128 v[92:95], v9 offset:5904
    ds_read_b128 v[96:99], v9 offset:224
    ds_read_b128 v[100:103], v9 offset:5936
    s_mul_i32 s10, s3, 3072
    s_add_u32 s10, s10, 68096
    v_and_b32 v1, 31, v0
    v_lshlrev_b32 v2, 5, v1
    v_lshl_add_u32 v2, v10, 4, v2
    v_add_u32 v2, s10, v2
    v_lshlrev_b32 v3, 4, v1
    v_add_u32 v3, 1024, v3
    v_lshlrev_b32 v4, 3, v1
    v_add_u32 v4, 1536, v4
    v_add_u32 v5, 8, v3
    v_add_u32 v6, 256, v4
    v_cmp_eq_u32 vcc, 0, v10
    s_nop 1
    v_cndmask_b32 v3, v4, v3, vcc
    v_cndmask_b32 v5, v6, v5, vcc
    v_add_u32 v3, s10, v3
    v_add_u32 v5, s10, v5
    v_lshlrev_b32 v6, 2, v1
    v_lshl_add_u32 v6, v10, 9, v6
    v_add_u32 v6, s10, v6
    s_waitcnt lgkmcnt(14)
    v_mfma_f32_32x32x16_f16 v[16:31], v[40:43], v[44:47], 0
    s_waitcnt lgkmcnt(12)
    v_mfma_f32_32x32x16_f16 v[16:31], v[48:51], v[52:55], v[16:31]
    s_waitcnt lgkmcnt(10)
    v_mfma_f32_32x32x16_f16 v[16:31], v[56:59], v[60:63], v[16:31]
    s_waitcnt lgkmcnt(8)
    v_mfma_f32_32x32x16_f16 v[16:31], v[64:67], v[68:71], v[16:31]
    s_waitcnt lgkmcnt(6)
    v_mfma_f32_32x32x16_f16 v[16:31], v[72:75], v[76:79], v[16:31]
    s_waitcnt lgkmcnt(4)
    v_mfma_f32_32x32x16_f16 v[16:31], v[80:83], v[84:87], v[16:31]
    s_waitcnt lgkmcnt(2)
    v_mfma_f32_32x32x16_f16 v[16:31], v[88:91], v[92:95], v[16:31]
    s_waitcnt lgkmcnt(0)
    v_mfma_f32_32x32x16_f16 v[16:31], v[96:99], v[100:103], v[16:31]
    v_and_b32 v204, 15, v0
    v_lshrrev_b32 v205, 4, v0
    v_mul_u32_u24 v203, 24576, v204
    v_lshlrev_b32 v206, 12, v205
    v_cmp_eq_u32 vcc, 3, v205
    v_mov_b32 v207, 8192
    s_nop 0
    v_cndmask_b32 v207, 0, v207, vcc
    v_add3_u32 v203, v203, v206, v207
    s_lshl_b32 s9, s97, 4
    s_add_u32 s9, s9, 524288
    v_add_u32 v203, s9, v203
    v_mul_u32_u24 v205, 24576, v204
    s_add_u32 s9, s9, 16384
    v_add_u32 v205, s9, v205
    s_lshl_b32 s9, s3, 12
    v_lshlrev_b32 v202, 4, v0
    v_add_u32 v202, s9, v202
    v_lshrrev_b32 v206, 2, v0
    v_lshlrev_b32 v206, 14, v206
    v_and_b32 v207, 3, v0
    v_lshl_add_u32 v206, v207, 4, v206
    s_lshl_b32 s9, s97, 6
    s_add_u32 s9, s9, 16777216
    s_lshl_b32 s4, s3, 20
    s_add_u32 s9, s9, s4
    v_add_u32 v206, s9, v206
    v_add_u32 v207, 0x40000, v206
    v_add_u32 v200, 0x80000, v206
    v_add_u32 v201, 0xC0000, v206
    v_mul_f32 v16, s13, v16
    v_mul_f32 v17, s13, v17
    v_mul_f32 v18, s13, v18
    v_mul_f32 v19, s13, v19
    v_mul_f32 v20, s13, v20
    v_mul_f32 v21, s13, v21
    v_mul_f32 v22, s13, v22
    v_mul_f32 v23, s13, v23
    v_mul_f32 v24, s13, v24
    v_mul_f32 v25, s13, v25
    v_mul_f32 v26, s13, v26
    v_mul_f32 v27, s13, v27
    ds_write_b128 v2, v[16:19]
    ds_write_b64 v3, v[20:21]
    ds_write_b64 v5, v[22:23]
    ds_write_b32 v6, v24 offset:2048
    ds_write_b32 v6, v25 offset:2176
    ds_write_b32 v6, v26 offset:2304
    ds_write_b32 v6, v27 offset:2432
    s_lshl_b32 s8, s7, 6
    v_add_u32 v1, s8, v0
    v_lshlrev_b32 v2, 3, v1
    v_sub_u32 v3, 2047, v2
    v_sub_u32 v4, 1023, v2
    v_cvt_f32_u32 v5, v3
    v_cvt_f32_u32 v6, v4
    v_lshlrev_b32 v7, 2, v4
    v_add_u32 v7, 68096, v7
    v_cmp_gt_u32 vcc, 256, v4
    v_mov_b32 v32, v5
    v_add_f32 v33, 0xbf800000, v5
    v_cvt_pk_bf16_f32 v34, v32, v33
    v_lshlrev_b32_sdwa v40, 2, v34 dst_sel:DWORD dst_unused:UNUSED_PAD src0_sel:DWORD src1_sel:WORD_0
    v_lshlrev_b32_sdwa v41, 2, v34 dst_sel:DWORD dst_unused:UNUSED_PAD src0_sel:DWORD src1_sel:WORD_1
    v_add_f32 v32, 0xc0000000, v5
    v_add_f32 v33, 0xc0400000, v5
    v_cvt_pk_bf16_f32 v34, v32, v33
    v_lshlrev_b32_sdwa v42, 2, v34 dst_sel:DWORD dst_unused:UNUSED_PAD src0_sel:DWORD src1_sel:WORD_0
    v_lshlrev_b32_sdwa v43, 2, v34 dst_sel:DWORD dst_unused:UNUSED_PAD src0_sel:DWORD src1_sel:WORD_1
    v_add_f32 v32, 0xc0800000, v5
    v_add_f32 v33, 0xc0a00000, v5
    v_cvt_pk_bf16_f32 v34, v32, v33
    v_lshlrev_b32_sdwa v44, 2, v34 dst_sel:DWORD dst_unused:UNUSED_PAD src0_sel:DWORD src1_sel:WORD_0
    v_lshlrev_b32_sdwa v45, 2, v34 dst_sel:DWORD dst_unused:UNUSED_PAD src0_sel:DWORD src1_sel:WORD_1
    v_add_f32 v32, 0xc0c00000, v5
    v_add_f32 v33, 0xc0e00000, v5
    v_cvt_pk_bf16_f32 v34, v32, v33
    v_lshlrev_b32_sdwa v46, 2, v34 dst_sel:DWORD dst_unused:UNUSED_PAD src0_sel:DWORD src1_sel:WORD_0
    v_lshlrev_b32_sdwa v47, 2, v34 dst_sel:DWORD dst_unused:UNUSED_PAD src0_sel:DWORD src1_sel:WORD_1
    v_add_f32 v32, 0xc1000000, v5
    v_add_f32 v33, 0xc1100000, v5
    v_cvt_pk_bf16_f32 v34, v32, v33
    v_lshlrev_b32_sdwa v48, 2, v34 dst_sel:DWORD dst_unused:UNUSED_PAD src0_sel:DWORD src1_sel:WORD_0
    v_mov_b32 v32, v6
    v_add_f32 v33, 0xbf800000, v6
    v_cvt_pk_bf16_f32 v34, v32, v33
    v_lshlrev_b32_sdwa v50, 2, v34 dst_sel:DWORD dst_unused:UNUSED_PAD src0_sel:DWORD src1_sel:WORD_0
    v_lshlrev_b32_sdwa v51, 2, v34 dst_sel:DWORD dst_unused:UNUSED_PAD src0_sel:DWORD src1_sel:WORD_1
    v_add_f32 v32, 0xc0000000, v6
    v_add_f32 v33, 0xc0400000, v6
    v_cvt_pk_bf16_f32 v34, v32, v33
    v_lshlrev_b32_sdwa v52, 2, v34 dst_sel:DWORD dst_unused:UNUSED_PAD src0_sel:DWORD src1_sel:WORD_0
    v_lshlrev_b32_sdwa v53, 2, v34 dst_sel:DWORD dst_unused:UNUSED_PAD src0_sel:DWORD src1_sel:WORD_1
    v_add_f32 v32, 0xc0800000, v6
    v_add_f32 v33, 0xc0a00000, v6
    v_cvt_pk_bf16_f32 v34, v32, v33
    v_lshlrev_b32_sdwa v54, 2, v34 dst_sel:DWORD dst_unused:UNUSED_PAD src0_sel:DWORD src1_sel:WORD_0
    v_lshlrev_b32_sdwa v55, 2, v34 dst_sel:DWORD dst_unused:UNUSED_PAD src0_sel:DWORD src1_sel:WORD_1
    v_add_f32 v32, 0xc0c00000, v6
    v_add_f32 v33, 0xc0e00000, v6
    v_cvt_pk_bf16_f32 v34, v32, v33
    v_lshlrev_b32_sdwa v56, 2, v34 dst_sel:DWORD dst_unused:UNUSED_PAD src0_sel:DWORD src1_sel:WORD_0
    v_lshlrev_b32_sdwa v57, 2, v34 dst_sel:DWORD dst_unused:UNUSED_PAD src0_sel:DWORD src1_sel:WORD_1
    v_add_f32 v32, 0xc1000000, v6
    v_add_f32 v33, 0xc1100000, v6
    v_cvt_pk_bf16_f32 v34, v32, v33
    v_lshlrev_b32_sdwa v58, 2, v34 dst_sel:DWORD dst_unused:UNUSED_PAD src0_sel:DWORD src1_sel:WORD_0
    v_subrev_u32 v35, 0, v7
    v_cndmask_b32 v50, v50, v35, vcc
    v_subrev_u32 v35, 4, v7
    v_cndmask_b32 v51, v51, v35, vcc
    v_subrev_u32 v35, 8, v7
    v_cndmask_b32 v52, v52, v35, vcc
    v_subrev_u32 v35, 12, v7
    v_cndmask_b32 v53, v53, v35, vcc
    v_subrev_u32 v35, 16, v7
    v_cndmask_b32 v54, v54, v35, vcc
    v_subrev_u32 v35, 20, v7
    v_cndmask_b32 v55, v55, v35, vcc
    v_subrev_u32 v35, 24, v7
    v_cndmask_b32 v56, v56, v35, vcc
    v_subrev_u32 v35, 28, v7
    v_cndmask_b32 v57, v57, v35, vcc
    v_subrev_u32 v35, 32, v7
    v_cndmask_b32 v58, v58, v35, vcc
    s_mul_i32 s8, s5, 6144
    v_add_u32 v40, s8, v40
    v_add_u32 v41, s8, v41
    v_add_u32 v42, s8, v42
    v_add_u32 v43, s8, v43
    v_add_u32 v44, s8, v44
    v_add_u32 v45, s8, v45
    v_add_u32 v46, s8, v46
    v_add_u32 v47, s8, v47
    v_add_u32 v48, s8, v48
    v_add_u32 v50, s8, v50
    v_add_u32 v51, s8, v51
    v_add_u32 v52, s8, v52
    v_add_u32 v53, s8, v53
    v_add_u32 v54, s8, v54
    v_add_u32 v55, s8, v55
    v_add_u32 v56, s8, v56
    v_add_u32 v57, s8, v57
    v_add_u32 v58, s8, v58
    v_cmp_eq_u32 vcc, 127, v1
    s_mul_i32 s8, s5, 8320
    s_add_u32 s8, s8, 80384
    v_lshlrev_b32 v2, 4, v1
    v_add_u32 v2, s8, v2
    v_mov_b32 v32, 0
    v_mov_b32 v33, 0
    v_mov_b32 v34, 0
    v_mov_b32 v35, 0
    v_and_b32 v4, 3, v1
    v_lshlrev_b32 v4, 4, v4
    v_bfe_u32 v5, v1, 2, 1
    v_mul_u32_u24 v5, 4160, v5
    v_add3_u32 v4, v4, v5, s8
    s_mul_i32 s9, s5, 4608
    s_add_u32 s9, s9, 97024
    v_lshlrev_b32 v5, 4, v0
    v_add_u32 v5, s9, v5
    s_cmp_eq_u32 s7, 0
    s_cbranch_scc0 KG_noz
    s_mov_b64 exec, 0xff
    ds_write_b128 v4, v[32:35] offset:4096
    s_mov_b64 exec, 0x3fffffff
    ds_write_b128 v5, v[32:35]
    s_mov_b64 exec, -1
KG_noz:
    s_and_b32 s100, s3, 3
    s_lshl_b32 s100, s100, 2
    s_add_u32 s100, s100, 163584
    v_mov_b32 v36, s100
    v_mov_b32 v228, 1
    s_waitcnt lgkmcnt(0)
    ds_write_b32 v36, v228
    v_and_b32 v36, 0xfffffff8, v36
    s_mov_b32 s98, 0
GB_1:
    ds_read_b64 v[228:229], v36
    s_waitcnt lgkmcnt(0)
    v_and_b32 v228, v228, v229
    s_nop 0
    v_readfirstlane_b32 s100, v228
    s_add_u32 s98, s98, 1
    s_cmp_gt_u32 s98, 320000
    s_cbranch_scc1 GBD_2
    s_cmp_eq_u32 s100, 1
    s_cbranch_scc0 GB_1
GBD_2:
    ds_read2st64_b32 v[60:61], v40 offset0:0 offset1:12
    ds_read2st64_b32 v[62:63], v41 offset0:0 offset1:12
    ds_read2st64_b32 v[64:65], v42 offset0:0 offset1:12
    ds_read2st64_b32 v[66:67], v43 offset0:0 offset1:12
    ds_read2st64_b32 v[68:69], v44 offset0:0 offset1:12
    ds_read2st64_b32 v[70:71], v45 offset0:0 offset1:12
    ds_read2st64_b32 v[72:73], v46 offset0:0 offset1:12
    ds_read2st64_b32 v[74:75], v47 offset0:0 offset1:12
    ds_read2st64_b32 v[76:77], v48 offset0:0 offset1:12
    ds_read2st64_b32 v[80:81], v50 offset0:0 offset1:12
    ds_read2st64_b32 v[82:83], v51 offset0:0 offset1:12
    ds_read2st64_b32 v[84:85], v52 offset0:0 offset1:12
    ds_read2st64_b32 v[86:87], v53 offset0:0 offset1:12
    ds_read2st64_b32 v[88:89], v54 offset0:0 offset1:12
    ds_read2st64_b32 v[90:91], v55 offset0:0 offset1:12
    ds_read2st64_b32 v[92:93], v56 offset0:0 offset1:12
    ds_read2st64_b32 v[94:95], v57 offset0:0 offset1:12
    ds_read2st64_b32 v[96:97], v58 offset0:0 offset1:12
    s_waitcnt lgkmcnt(9)
    v_add_f32 v60, v60, v61
    v_add_f32 v62, v62, v63
    v_add_f32 v64, v64, v65
    v_add_f32 v66, v66, v67
    v_add_f32 v68, v68, v69
    v_add_f32 v70, v70, v71
    v_add_f32 v72, v72, v73
    v_add_f32 v74, v74, v75
    v_add_f32 v76, v76, v77
    v_cvt_pk_bf16_f32 v16, v60, v62
    v_cvt_pk_bf16_f32 v20, v62, v64
    v_cvt_pk_bf16_f32 v17, v64, v66
    v_cvt_pk_bf16_f32 v21, v66, v68
    v_cvt_pk_bf16_f32 v18, v68, v70
    v_cvt_pk_bf16_f32 v22, v70, v72
    v_cvt_pk_bf16_f32 v19, v72, v74
    v_cvt_pk_bf16_f32 v23, v74, v76
    ds_write_b128 v2, v[16:19] offset:0
    ds_write_b128 v2, v[20:23] offset:4160
    s_waitcnt lgkmcnt(2)
    v_add_f32 v80, v80, v81
    v_add_f32 v82, v82, v83
    v_add_f32 v84, v84, v85
    v_add_f32 v86, v86, v87
    v_add_f32 v88, v88, v89
    v_add_f32 v90, v90, v91
    v_add_f32 v92, v92, v93
    v_add_f32 v94, v94, v95
    v_add_f32 v96, v96, v97
    v_cndmask_b32 v96, v96, 0, vcc
    v_cvt_pk_bf16_f32 v24, v80, v82
    v_cvt_pk_bf16_f32 v28, v82, v84
    v_cvt_pk_bf16_f32 v25, v84, v86
    v_cvt_pk_bf16_f32 v29, v86, v88
    v_cvt_pk_bf16_f32 v26, v88, v90
    v_cvt_pk_bf16_f32 v30, v90, v92
    v_cvt_pk_bf16_f32 v27, v92, v94
    v_cvt_pk_bf16_f32 v31, v94, v96
    ds_write_b128 v2, v[24:27] offset:2048
    ds_write_b128 v2, v[28:31] offset:6208
    v_and_b32 v4, 15, v0
    v_lshrrev_b32 v5, 4, v0
    s_lshl_b32 s54, s7, 8
    s_sub_u32 s53, s8, s54
    s_add_u32 s53, s53, 3870
    v_lshlrev_b32 v40, 4, v5
    v_lshlrev_b32 v41, 1, v4
    v_sub_u32 v40, v40, v41
    v_add_u32 v40, s53, v40
    v_and_b32 v41, 1, v4
    v_cmp_eq_u32 vcc, 0, v41
    v_mov_b32 v42, 4158
    s_nop 0
    v_cndmask_b32 v41, 0, v42, vcc
    v_add_u32 v40, v40, v41
    s_sub_u32 s53, s9, s54
    s_add_u32 s53, s53, 256
    v_lshlrev_b32 v48, 5, v4
    v_lshl_add_u32 v48, v5, 4, v48
    v_add_u32 v48, s53, v48
    s_mul_i32 s53, s3, 10240
    s_add_u32 s53, s53, 0
    v_mul_u32_u24 v49, 320, v5
    v_lshl_add_u32 v49, v4, 4, v49
    v_add_u32 v49, s53, v49
    s_lshl_b32 s53, s3, 10
    s_add_u32 s53, s53, 97504
    v_lshlrev_b32 v9, 2, v0
    v_add_u32 v9, s53, v9
    s_mov_b32 s10, 0x05040100
    s_mov_b32 s11, 0x07060302
    v_subrev_u32 v41, 512, v40
    v_subrev_u32 v42, 1024, v40
    v_subrev_u32 v43, 1536, v40
    v_subrev_u32 v44, 2048, v40
    v_subrev_u32 v45, 2560, v40
    v_subrev_u32 v46, 3072, v40
    v_subrev_u32 v47, 3584, v40
    s_sleep 12
.L_PADBEG:
    global_load_dwordx4 v[184:187], v206, s[46:47] sc1
    global_load_dwordx4 v[188:191], v207, s[46:47] sc1
    global_load_dwordx4 v[192:195], v200, s[46:47] sc1
    global_load_dwordx4 v[196:199], v201, s[46:47] sc1
    global_load_dwordx4 v[208:211], v202, s[46:47] offset:0 sc1
    global_load_dwordx4 v[212:215], v202, s[46:47] offset:1024 sc1
    global_load_dwordx4 v[216:219], v202, s[46:47] offset:2048 sc1
    global_load_dwordx4 v[220:223], v202, s[46:47] offset:3072 sc1
    global_load_dwordx4 v[224:227], v203, s[46:47] sc1
    global_load_dwordx4 v[252:255], v205, s[46:47] sc1
    s_and_b32 s100, s3, 3
    s_lshl_b32 s100, s100, 2
    s_add_u32 s100, s100, 163680
    v_mov_b32 v36, s100
    v_mov_b32 v228, 1
    s_waitcnt lgkmcnt(0)
    ds_write_b32 v36, v228
    s_mov_b32 s98, 0
    s_branch POLM_5
POL_3:
    global_load_dwordx4 v[184:187], v206, s[46:47] sc1
    global_load_dwordx4 v[188:191], v207, s[46:47] sc1
    global_load_dwordx4 v[192:195], v200, s[46:47] sc1
    global_load_dwordx4 v[196:199], v201, s[46:47] sc1
    global_load_dwordx4 v[208:211], v202, s[46:47] offset:0 sc1
    global_load_dwordx4 v[212:215], v202, s[46:47] offset:1024 sc1
    global_load_dwordx4 v[216:219], v202, s[46:47] offset:2048 sc1
    global_load_dwordx4 v[220:223], v202, s[46:47] offset:3072 sc1
    global_load_dwordx4 v[224:227], v203, s[46:47] sc1
    global_load_dwordx4 v[252:255], v205, s[46:47] sc1
POLM_5:
    s_mov_b64 exec, -1
    s_waitcnt vmcnt(0)
POLN_6:
    v_cmp_ne_u32 vcc, s96, v185
    v_cmp_ne_u32 s[100:101], s96, v187
    s_nop 1
    s_or_b64 vcc, vcc, s[100:101]
    v_cmp_ne_u32 s[100:101], s96, v189
    s_nop 1
    s_or_b64 vcc, vcc, s[100:101]
    v_cmp_ne_u32 s[100:101], s96, v191
    s_nop 1
    s_or_b64 vcc, vcc, s[100:101]
    v_cmp_ne_u32 s[100:101], s96, v193
    s_nop 1
    s_or_b64 vcc, vcc, s[100:101]
    v_cmp_ne_u32 s[100:101], s96, v195
    s_nop 1
    s_or_b64 vcc, vcc, s[100:101]
    v_cmp_ne_u32 s[100:101], s96, v197
    s_nop 1
    s_or_b64 vcc, vcc, s[100:101]
    v_cmp_ne_u32 s[100:101], s96, v199
    s_nop 1
    s_or_b64 vcc, vcc, s[100:101]
    v_cmp_ne_u32 s[100:101], s96, v209
    s_nop 1
    s_or_b64 vcc, vcc, s[100:101]
    v_cmp_ne_u32 s[100:101], s96, v211
    s_nop 1
    s_or_b64 vcc, vcc, s[100:101]
    v_cmp_ne_u32 s[100:101], s96, v213
    s_nop 1
    s_or_b64 vcc, vcc, s[100:101]
    v_cmp_ne_u32 s[100:101], s96, v215
    s_nop 1
    s_or_b64 vcc, vcc, s[100:101]
    v_cmp_ne_u32 s[100:101], s96, v217
    s_nop 1
    s_or_b64 vcc, vcc, s[100:101]
    v_cmp_ne_u32 s[100:101], s96, v219
    s_nop 1
    s_or_b64 vcc, vcc, s[100:101]
    v_cmp_ne_u32 s[100:101], s96, v221
    s_nop 1
    s_or_b64 vcc, vcc, s[100:101]
    v_cmp_ne_u32 s[100:101], s96, v223
    s_nop 1
    s_or_b64 vcc, vcc, s[100:101]
    v_cmp_ne_u32 s[100:101], s96, v225
    s_nop 1
    s_or_b64 vcc, vcc, s[100:101]
    v_cmp_ne_u32 s[100:101], s96, v227
    s_nop 1
    s_or_b64 vcc, vcc, s[100:101]
    v_cmp_ne_u32 s[100:101], s96, v253
    s_nop 1
    s_or_b64 vcc, vcc, s[100:101]
    v_cmp_ne_u32 s[100:101], s96, v255
    s_nop 1
    s_or_b64 vcc, vcc, s[100:101]
    s_add_u32 s98, s98, 1
    s_cmp_gt_u32 s98, 40000
    s_cbranch_scc1 POLD_4
    s_cmp_eq_u64 vcc, 0
    s_cbranch_scc1 POLD_4
    s_mov_b64 exec, vcc
    s_sleep 8
    s_branch POL_3
POLD_4:
    v_add_f32 v224, v224, v224 row_shr:1 bound_ctrl:0
    v_add_f32 v226, v226, v226 row_shr:1 bound_ctrl:0
    v_add_f32 v252, v252, v252 row_shr:1 bound_ctrl:0
    v_add_f32 v254, v254, v254 row_shr:1 bound_ctrl:0
    v_add_f32 v224, v224, v224 row_shr:2 bound_ctrl:0
    v_add_f32 v226, v226, v226 row_shr:2 bound_ctrl:0
    v_add_f32 v252, v252, v252 row_shr:2 bound_ctrl:0
    v_add_f32 v254, v254, v254 row_shr:2 bound_ctrl:0
    v_add_f32 v224, v224, v224 row_shr:4 bound_ctrl:0
    v_add_f32 v226, v226, v226 row_shr:4 bound_ctrl:0
    v_add_f32 v252, v252, v252 row_shr:4 bound_ctrl:0
    v_add_f32 v254, v254, v254 row_shr:4 bound_ctrl:0
    v_add_f32 v224, v224, v224 row_shr:8 bound_ctrl:0
    v_add_f32 v226, v226, v226 row_shr:8 bound_ctrl:0
    v_add_f32 v252, v252, v252 row_shr:8 bound_ctrl:0
    v_add_f32 v254, v254, v254 row_shr:8 bound_ctrl:0
    v_cvt_pk_bf16_f32 v10, v224, v226
    v_cvt_pk_bf16_f32 v11, v252, v254
    v_lshlrev_b32 v12, 16, v11
    v_and_b32 v11, 0xffff0000, v11
    v_add_f32 v12, 1.0, v12
    v_add_f32 v11, 1.0, v11
    v_cvt_pk_bf16_f32 v11, v12, v11
    s_nop 0
    v_readlane_b32 s52, v11, 15
    v_readlane_b32 s54, v10, 15
    v_readlane_b32 s55, v10, 31
    v_readlane_b32 s56, v10, 47
    v_readlane_b32 s57, v10, 63
    s_lshl_b32 s58, s54, 16
    s_and_b32 s59, s54, 0xffff0000
    s_lshl_b32 s60, s55, 16
    s_and_b32 s61, s55, 0xffff0000
    v_add_f32 v10, 1.0, s60
    v_add_f32 v11, 1.0, s61
    v_cvt_pk_bf16_f32 v10, v10, v11
    s_nop 0
    v_readfirstlane_b32 s55, v10
    s_nop 1
    s_lshl_b32 s60, s55, 16
    s_and_b32 s61, s55, 0xffff0000
    v_mov_b32 v10, s57
    s_lshl_b32 s4, s97, 2
    s_add_u32 s4, s4, 65536
    v_mov_b32 v12, s4
    s_cmp_eq_u32 s3, 0
    s_cbranch_scc0 KG_nogb
    s_mov_b64 exec, 1
    global_store_dword v12, v10, s[46:47] sc1
    s_mov_b64 exec, -1
KG_nogb:
    v_and_b32 v32, 0xffff0000, v208
    v_lshlrev_b32 v24, 16, v208
    v_and_b32 v33, 0xffff0000, v210
    v_lshlrev_b32 v25, 16, v210
    v_and_b32 v34, 0xffff0000, v212
    v_lshlrev_b32 v26, 16, v212
    v_and_b32 v35, 0xffff0000, v214
    v_lshlrev_b32 v27, 16, v214
    v_and_b32 v36, 0xffff0000, v216
    v_lshlrev_b32 v28, 16, v216
    v_and_b32 v37, 0xffff0000, v218
    v_lshlrev_b32 v29, 16, v218
    v_and_b32 v38, 0xffff0000, v220
    v_lshlrev_b32 v30, 16, v220
    v_and_b32 v39, 0xffff0000, v222
    v_lshlrev_b32 v31, 16, v222
    v_rcp_f32 v32, v32
    v_rcp_f32 v33, v33
    v_rcp_f32 v34, v34
    v_rcp_f32 v35, v35
    v_rcp_f32 v36, v36
    v_rcp_f32 v37, v37
    v_rcp_f32 v38, v38
    v_rcp_f32 v39, v39
    v_lshlrev_b32 v60, 16, v184
    v_lshlrev_b32 v61, 16, v186
    v_perm_b32 v63, v186, v184, s10
    v_sub_f32 v60, v60, v24
    v_sub_f32 v61, v61, v25
    ds_write_b32 v9, v63 offset:12832
    v_cvt_pk_bf16_f32 v62, v60, v61
    v_lshlrev_b32 v60, 16, v62
    v_and_b32 v61, 0xffff0000, v62
    v_mul_f32 v60, v60, v32
    v_mul_f32 v61, v61, v33
    v_cvt_pk_bf16_f32 v62, v60, v61
    v_lshlrev_b32 v60, 16, v62
    v_and_b32 v61, 0xffff0000, v62
    v_mul_f32 v60, s60, v60
    v_mul_f32 v61, s60, v61
    v_cvt_pk_bf16_f32 v62, v60, v61
    v_lshlrev_b32 v60, 16, v62
    v_and_b32 v61, 0xffff0000, v62
    v_add_f32 v60, s58, v60
    v_add_f32 v61, s58, v61
    v_cvt_pk_bf16_f32 v62, v60, v61
    ds_write_b32 v9, v62 offset:0
    v_and_b32 v64, 0xffff0000, v184
    v_and_b32 v65, 0xffff0000, v186
    v_perm_b32 v67, v186, v184, s11
    v_sub_f32 v64, v64, v24
    v_sub_f32 v65, v65, v25
    ds_write_b32 v9, v67 offset:16928
    v_cvt_pk_bf16_f32 v66, v64, v65
    v_lshlrev_b32 v64, 16, v66
    v_and_b32 v65, 0xffff0000, v66
    v_mul_f32 v64, v64, v32
    v_mul_f32 v65, v65, v33
    v_cvt_pk_bf16_f32 v66, v64, v65
    v_lshlrev_b32 v64, 16, v66
    v_and_b32 v65, 0xffff0000, v66
    v_mul_f32 v64, s61, v64
    v_mul_f32 v65, s61, v65
    v_cvt_pk_bf16_f32 v66, v64, v65
    v_lshlrev_b32 v64, 16, v66
    v_and_b32 v65, 0xffff0000, v66
    v_add_f32 v64, s59, v64
    v_add_f32 v65, s59, v65
    v_cvt_pk_bf16_f32 v66, v64, v65
    ds_write_b32 v9, v66 offset:4608
    v_lshlrev_b32 v60, 16, v188
    v_lshlrev_b32 v61, 16, v190
    v_perm_b32 v63, v190, v188, s10
    v_sub_f32 v60, v60, v26
    v_sub_f32 v61, v61, v27
    ds_write_b32 v9, v63 offset:13088
    v_cvt_pk_bf16_f32 v62, v60, v61
    v_lshlrev_b32 v60, 16, v62
    v_and_b32 v61, 0xffff0000, v62
    v_mul_f32 v60, v60, v34
    v_mul_f32 v61, v61, v35
    v_cvt_pk_bf16_f32 v62, v60, v61
    v_lshlrev_b32 v60, 16, v62
    v_and_b32 v61, 0xffff0000, v62
    v_mul_f32 v60, s60, v60
    v_mul_f32 v61, s60, v61
    v_cvt_pk_bf16_f32 v62, v60, v61
    v_lshlrev_b32 v60, 16, v62
    v_and_b32 v61, 0xffff0000, v62
    v_add_f32 v60, s58, v60
    v_add_f32 v61, s58, v61
    v_cvt_pk_bf16_f32 v62, v60, v61
    ds_write_b32 v9, v62 offset:256
    v_and_b32 v64, 0xffff0000, v188
    v_and_b32 v65, 0xffff0000, v190
    v_perm_b32 v67, v190, v188, s11
    v_sub_f32 v64, v64, v26
    v_sub_f32 v65, v65, v27
    ds_write_b32 v9, v67 offset:17184
    v_cvt_pk_bf16_f32 v66, v64, v65
    v_lshlrev_b32 v64, 16, v66
    v_and_b32 v65, 0xffff0000, v66
    v_mul_f32 v64, v64, v34
    v_mul_f32 v65, v65, v35
    v_cvt_pk_bf16_f32 v66, v64, v65
    v_lshlrev_b32 v64, 16, v66
    v_and_b32 v65, 0xffff0000, v66
    v_mul_f32 v64, s61, v64
    v_mul_f32 v65, s61, v65
    v_cvt_pk_bf16_f32 v66, v64, v65
    v_lshlrev_b32 v64, 16, v66
    v_and_b32 v65, 0xffff0000, v66
    v_add_f32 v64, s59, v64
    v_add_f32 v65, s59, v65
    v_cvt_pk_bf16_f32 v66, v64, v65
    ds_write_b32 v9, v66 offset:4864
    v_lshlrev_b32 v60, 16, v192
    v_lshlrev_b32 v61, 16, v194
    v_perm_b32 v63, v194, v192, s10
    v_sub_f32 v60, v60, v28
    v_sub_f32 v61, v61, v29
    ds_write_b32 v9, v63 offset:13344
    v_cvt_pk_bf16_f32 v62, v60, v61
    v_lshlrev_b32 v60, 16, v62
    v_and_b32 v61, 0xffff0000, v62
    v_mul_f32 v60, v60, v36
    v_mul_f32 v61, v61, v37
    v_cvt_pk_bf16_f32 v62, v60, v61
    v_lshlrev_b32 v60, 16, v62
    v_and_b32 v61, 0xffff0000, v62
    v_mul_f32 v60, s60, v60
    v_mul_f32 v61, s60, v61
    v_cvt_pk_bf16_f32 v62, v60, v61
    v_lshlrev_b32 v60, 16, v62
    v_and_b32 v61, 0xffff0000, v62
    v_add_f32 v60, s58, v60
    v_add_f32 v61, s58, v61
    v_cvt_pk_bf16_f32 v62, v60, v61
    ds_write_b32 v9, v62 offset:512
    v_and_b32 v64, 0xffff0000, v192
    v_and_b32 v65, 0xffff0000, v194
    v_perm_b32 v67, v194, v192, s11
    v_sub_f32 v64, v64, v28
    v_sub_f32 v65, v65, v29
    ds_write_b32 v9, v67 offset:17440
    v_cvt_pk_bf16_f32 v66, v64, v65
    v_lshlrev_b32 v64, 16, v66
    v_and_b32 v65, 0xffff0000, v66
    v_mul_f32 v64, v64, v36
    v_mul_f32 v65, v65, v37
    v_cvt_pk_bf16_f32 v66, v64, v65
    v_lshlrev_b32 v64, 16, v66
    v_and_b32 v65, 0xffff0000, v66
    v_mul_f32 v64, s61, v64
    v_mul_f32 v65, s61, v65
    v_cvt_pk_bf16_f32 v66, v64, v65
    v_lshlrev_b32 v64, 16, v66
    v_and_b32 v65, 0xffff0000, v66
    v_add_f32 v64, s59, v64
    v_add_f32 v65, s59, v65
    v_cvt_pk_bf16_f32 v66, v64, v65
    ds_write_b32 v9, v66 offset:5120
    v_lshlrev_b32 v60, 16, v196
    v_lshlrev_b32 v61, 16, v198
    v_perm_b32 v63, v198, v196, s10
    v_sub_f32 v60, v60, v30
    v_sub_f32 v61, v61, v31
    ds_write_b32 v9, v63 offset:13600
    v_cvt_pk_bf16_f32 v62, v60, v61
    v_lshlrev_b32 v60, 16, v62
    v_and_b32 v61, 0xffff0000, v62
    v_mul_f32 v60, v60, v38
    v_mul_f32 v61, v61, v39
    v_cvt_pk_bf16_f32 v62, v60, v61
    v_lshlrev_b32 v60, 16, v62
    v_and_b32 v61, 0xffff0000, v62
    v_mul_f32 v60, s60, v60
    v_mul_f32 v61, s60, v61
    v_cvt_pk_bf16_f32 v62, v60, v61
    v_lshlrev_b32 v60, 16, v62
    v_and_b32 v61, 0xffff0000, v62
    v_add_f32 v60, s58, v60
    v_add_f32 v61, s58, v61
    v_cvt_pk_bf16_f32 v62, v60, v61
    ds_write_b32 v9, v62 offset:768
    v_and_b32 v64, 0xffff0000, v196
    v_and_b32 v65, 0xffff0000, v198
    v_perm_b32 v67, v198, v196, s11
    v_sub_f32 v64, v64, v30
    v_sub_f32 v65, v65, v31
    ds_write_b32 v9, v67 offset:17696
    v_cvt_pk_bf16_f32 v66, v64, v65
    v_lshlrev_b32 v64, 16, v66
    v_and_b32 v65, 0xffff0000, v66
    v_mul_f32 v64, v64, v38
    v_mul_f32 v65, v65, v39
    v_cvt_pk_bf16_f32 v66, v64, v65
    v_lshlrev_b32 v64, 16, v66
    v_and_b32 v65, 0xffff0000, v66
    v_mul_f32 v64, s61, v64
    v_mul_f32 v65, s61, v65
    v_cvt_pk_bf16_f32 v66, v64, v65
    v_lshlrev_b32 v64, 16, v66
    v_and_b32 v65, 0xffff0000, v66
    v_add_f32 v64, s59, v64
    v_add_f32 v65, s59, v65
    v_cvt_pk_bf16_f32 v66, v64, v65
    ds_write_b32 v9, v66 offset:5376
    s_and_b32 s100, s3, 3
    s_lshl_b32 s100, s100, 2
    s_add_u32 s100, s100, 163600
    v_mov_b32 v36, s100
    v_mov_b32 v228, 1
    s_waitcnt lgkmcnt(0)
    ds_write_b32 v36, v228
    v_mov_b32 v36, 163600
    s_mov_b32 s98, 0
GB_7:
    ds_read_b128 v[228:231], v36
    s_waitcnt lgkmcnt(0)
    v_and_b32 v228, v228, v229
    v_and_b32 v228, v228, v230
    v_and_b32 v228, v228, v231
    s_nop 0
    v_readfirstlane_b32 s100, v228
    s_add_u32 s98, s98, 1
    s_cmp_gt_u32 s98, 320000
    s_cbranch_scc1 GBD_8
    s_cmp_eq_u32 s100, 1
    s_cbranch_scc0 GB_7
GBD_8:
    ds_read_b128 v[128:131], v48 offset:192
    ds_read2_b32 v[96:97], v40 offset0:48 offset1:49
    ds_read2_b32 v[98:99], v40 offset0:50 offset1:51
    ds_read_b128 v[132:135], v48 offset:704
    ds_read2_b32 v[100:101], v41 offset0:48 offset1:49
    ds_read2_b32 v[102:103], v41 offset0:50 offset1:51
    ds_read_b128 v[136:139], v48 offset:1216
    ds_read2_b32 v[104:105], v42 offset0:48 offset1:49
    ds_read2_b32 v[106:107], v42 offset0:50 offset1:51
    ds_read_b128 v[140:143], v48 offset:1728
    ds_read2_b32 v[108:109], v43 offset0:48 offset1:49
    ds_read2_b32 v[110:111], v43 offset0:50 offset1:51
    ds_read_b128 v[144:147], v48 offset:2240
    ds_read2_b32 v[112:113], v44 offset0:48 offset1:49
    ds_read2_b32 v[114:115], v44 offset0:50 offset1:51
    s_waitcnt lgkmcnt(12)
    v_mfma_f32_16x16x32_bf16 v[64:67], v[96:99], v[128:131], 0
    ds_read_b128 v[148:151], v48 offset:2752
    s_waitcnt lgkmcnt(10)
    v_mfma_f32_16x16x32_bf16 v[68:71], v[100:103], v[128:131], 0
    ds_read2_b32 v[116:117], v45 offset0:48 offset1:49
    v_mfma_f32_16x16x32_bf16 v[72:75], v[100:103], v[132:135], 0
    ds_read2_b32 v[118:119], v45 offset0:50 offset1:51
    v_mfma_f32_16x16x32_bf16 v[68:71], v[96:99], v[132:135], v[68:71]
    ds_read_b128 v[152:155], v48 offset:3264
    s_waitcnt lgkmcnt(10)
    v_mfma_f32_16x16x32_bf16 v[72:75], v[104:107], v[128:131], v[72:75]
    ds_read2_b32 v[120:121], v46 offset0:48 offset1:49
    v_mfma_f32_16x16x32_bf16 v[76:79], v[104:107], v[132:135], 0
    ds_read2_b32 v[122:123], v46 offset0:50 offset1:51
    v_mfma_f32_16x16x32_bf16 v[80:83], v[104:107], v[136:139], 0
    ds_read_b128 v[156:159], v48 offset:3776
    v_mfma_f32_16x16x32_bf16 v[72:75], v[96:99], v[136:139], v[72:75]
    ds_read2_b32 v[124:125], v47 offset0:48 offset1:49
    v_mfma_f32_16x16x32_bf16 v[76:79], v[100:103], v[136:139], v[76:79]
    ds_read2_b32 v[126:127], v47 offset0:50 offset1:51
    s_waitcnt lgkmcnt(12)
    v_mfma_f32_16x16x32_bf16 v[76:79], v[108:111], v[128:131], v[76:79]
    ds_read_b128 v[192:195], v48 offset:128
    v_mfma_f32_16x16x32_bf16 v[80:83], v[108:111], v[132:135], v[80:83]
    ds_read2_b32 v[160:161], v40 offset0:32 offset1:33
    v_mfma_f32_16x16x32_bf16 v[84:87], v[108:111], v[136:139], 0
    ds_read2_b32 v[162:163], v40 offset0:34 offset1:35
    v_mfma_f32_16x16x32_bf16 v[88:91], v[108:111], v[140:143], 0
    v_mfma_f32_16x16x32_bf16 v[76:79], v[96:99], v[140:143], v[76:79]
    v_mfma_f32_16x16x32_bf16 v[80:83], v[100:103], v[140:143], v[80:83]
    v_mfma_f32_16x16x32_bf16 v[84:87], v[104:107], v[140:143], v[84:87]
    s_waitcnt lgkmcnt(12)
    v_mfma_f32_16x16x32_bf16 v[80:83], v[112:115], v[128:131], v[80:83]
    ds_read_b128 v[196:199], v48 offset:640
    v_mfma_f32_16x16x32_bf16 v[84:87], v[112:115], v[132:135], v[84:87]
    ds_read2_b32 v[164:165], v41 offset0:32 offset1:33
    v_mfma_f32_16x16x32_bf16 v[88:91], v[112:115], v[136:139], v[88:91]
    ds_read2_b32 v[166:167], v41 offset0:34 offset1:35
    v_mfma_f32_16x16x32_bf16 v[92:95], v[112:115], v[140:143], 0
    v_mfma_f32_16x16x32_bf16 v[80:83], v[96:99], v[144:147], v[80:83]
    v_mfma_f32_16x16x32_bf16 v[84:87], v[100:103], v[144:147], v[84:87]
    v_mfma_f32_16x16x32_bf16 v[88:91], v[104:107], v[144:147], v[88:91]
    v_mfma_f32_16x16x32_bf16 v[92:95], v[108:111], v[144:147], v[92:95]
    s_waitcnt lgkmcnt(12)
    v_mfma_f32_16x16x32_bf16 v[84:87], v[116:119], v[128:131], v[84:87]
    ds_read_b128 v[200:203], v48 offset:1152
    v_mfma_f32_16x16x32_bf16 v[88:91], v[116:119], v[132:135], v[88:91]
    ds_read2_b32 v[168:169], v42 offset0:32 offset1:33
    v_mfma_f32_16x16x32_bf16 v[92:95], v[116:119], v[136:139], v[92:95]
    ds_read2_b32 v[170:171], v42 offset0:34 offset1:35
    v_mfma_f32_16x16x32_bf16 v[84:87], v[96:99], v[148:151], v[84:87]
    v_mfma_f32_16x16x32_bf16 v[88:91], v[100:103], v[148:151], v[88:91]
    v_mfma_f32_16x16x32_bf16 v[92:95], v[104:107], v[148:151], v[92:95]
    s_waitcnt lgkmcnt(12)
    v_mfma_f32_16x16x32_bf16 v[88:91], v[120:123], v[128:131], v[88:91]
    ds_read_b128 v[204:207], v48 offset:1664
    v_mfma_f32_16x16x32_bf16 v[92:95], v[120:123], v[132:135], v[92:95]
    ds_read2_b32 v[172:173], v43 offset0:32 offset1:33
    v_mfma_f32_16x16x32_bf16 v[88:91], v[96:99], v[152:155], v[88:91]
    ds_read2_b32 v[174:175], v43 offset0:34 offset1:35
    v_mfma_f32_16x16x32_bf16 v[92:95], v[100:103], v[152:155], v[92:95]
    s_waitcnt lgkmcnt(12)
    v_mfma_f32_16x16x32_bf16 v[92:95], v[124:127], v[128:131], v[92:95]
    ds_read_b128 v[208:211], v48 offset:2176
    v_mfma_f32_16x16x32_bf16 v[92:95], v[96:99], v[156:159], v[92:95]
    ds_read2_b32 v[176:177], v44 offset0:32 offset1:33
    s_waitcnt lgkmcnt(11)
    v_mfma_f32_16x16x32_bf16 v[64:67], v[160:163], v[192:195], v[64:67]
    ds_read2_b32 v[178:179], v44 offset0:34 offset1:35
    s_waitcnt lgkmcnt(9)
    v_mfma_f32_16x16x32_bf16 v[68:71], v[164:167], v[192:195], v[68:71]
    ds_read_b128 v[212:215], v48 offset:2688
    v_mfma_f32_16x16x32_bf16 v[72:75], v[164:167], v[196:199], v[72:75]
    ds_read2_b32 v[180:181], v45 offset0:32 offset1:33
    v_mfma_f32_16x16x32_bf16 v[68:71], v[160:163], v[196:199], v[68:71]
    ds_read2_b32 v[182:183], v45 offset0:34 offset1:35
    s_waitcnt lgkmcnt(9)
    v_mfma_f32_16x16x32_bf16 v[72:75], v[168:171], v[192:195], v[72:75]
    ds_read_b128 v[216:219], v48 offset:3200
    v_mfma_f32_16x16x32_bf16 v[76:79], v[168:171], v[196:199], v[76:79]
    ds_read2_b32 v[184:185], v46 offset0:32 offset1:33
    v_mfma_f32_16x16x32_bf16 v[80:83], v[168:171], v[200:203], v[80:83]
    ds_read2_b32 v[186:187], v46 offset0:34 offset1:35
    v_mfma_f32_16x16x32_bf16 v[72:75], v[160:163], v[200:203], v[72:75]
    ds_read_b128 v[220:223], v48 offset:3712
    v_mfma_f32_16x16x32_bf16 v[76:79], v[164:167], v[200:203], v[76:79]
    ds_read2_b32 v[188:189], v47 offset0:32 offset1:33
    s_waitcnt lgkmcnt(11)
    v_mfma_f32_16x16x32_bf16 v[76:79], v[172:175], v[192:195], v[76:79]
    ds_read2_b32 v[190:191], v47 offset0:34 offset1:35
    v_mfma_f32_16x16x32_bf16 v[80:83], v[172:175], v[196:199], v[80:83]
    ds_read_b128 v[128:131], v48 offset:64
    v_mfma_f32_16x16x32_bf16 v[84:87], v[172:175], v[200:203], v[84:87]
    ds_read2_b32 v[96:97], v40 offset0:16 offset1:17
    v_mfma_f32_16x16x32_bf16 v[88:91], v[172:175], v[204:207], v[88:91]
    ds_read2_b32 v[98:99], v40 offset0:18 offset1:19
    v_mfma_f32_16x16x32_bf16 v[76:79], v[160:163], v[204:207], v[76:79]
    v_mfma_f32_16x16x32_bf16 v[80:83], v[164:167], v[204:207], v[80:83]
    v_mfma_f32_16x16x32_bf16 v[84:87], v[168:171], v[204:207], v[84:87]
    s_waitcnt lgkmcnt(12)
    v_mfma_f32_16x16x32_bf16 v[80:83], v[176:179], v[192:195], v[80:83]
    ds_read_b128 v[132:135], v48 offset:576
    v_mfma_f32_16x16x32_bf16 v[84:87], v[176:179], v[196:199], v[84:87]
    ds_read2_b32 v[100:101], v41 offset0:16 offset1:17
    v_mfma_f32_16x16x32_bf16 v[88:91], v[176:179], v[200:203], v[88:91]
    ds_read2_b32 v[102:103], v41 offset0:18 offset1:19
    v_mfma_f32_16x16x32_bf16 v[92:95], v[176:179], v[204:207], v[92:95]
    v_mfma_f32_16x16x32_bf16 v[80:83], v[160:163], v[208:211], v[80:83]
    v_mfma_f32_16x16x32_bf16 v[84:87], v[164:167], v[208:211], v[84:87]
    v_mfma_f32_16x16x32_bf16 v[88:91], v[168:171], v[208:211], v[88:91]
    v_mfma_f32_16x16x32_bf16 v[92:95], v[172:175], v[208:211], v[92:95]
    s_waitcnt lgkmcnt(12)
    v_mfma_f32_16x16x32_bf16 v[84:87], v[180:183], v[192:195], v[84:87]
    ds_read_b128 v[136:139], v48 offset:1088
    v_mfma_f32_16x16x32_bf16 v[88:91], v[180:183], v[196:199], v[88:91]
    ds_read2_b32 v[104:105], v42 offset0:16 offset1:17
    v_mfma_f32_16x16x32_bf16 v[92:95], v[180:183], v[200:203], v[92:95]
    ds_read2_b32 v[106:107], v42 offset0:18 offset1:19
    v_mfma_f32_16x16x32_bf16 v[84:87], v[160:163], v[212:215], v[84:87]
    v_mfma_f32_16x16x32_bf16 v[88:91], v[164:167], v[212:215], v[88:91]
    v_mfma_f32_16x16x32_bf16 v[92:95], v[168:171], v[212:215], v[92:95]
    s_waitcnt lgkmcnt(12)
    v_mfma_f32_16x16x32_bf16 v[88:91], v[184:187], v[192:195], v[88:91]
    ds_read_b128 v[140:143], v48 offset:1600
    v_mfma_f32_16x16x32_bf16 v[92:95], v[184:187], v[196:199], v[92:95]
    ds_read2_b32 v[108:109], v43 offset0:16 offset1:17
    v_mfma_f32_16x16x32_bf16 v[88:91], v[160:163], v[216:219], v[88:91]
    ds_read2_b32 v[110:111], v43 offset0:18 offset1:19
    v_mfma_f32_16x16x32_bf16 v[92:95], v[164:167], v[216:219], v[92:95]
    s_waitcnt lgkmcnt(12)
    v_mfma_f32_16x16x32_bf16 v[92:95], v[188:191], v[192:195], v[92:95]
    ds_read_b128 v[144:147], v48 offset:2112
    v_mfma_f32_16x16x32_bf16 v[92:95], v[160:163], v[220:223], v[92:95]
    ds_read2_b32 v[112:113], v44 offset0:16 offset1:17
    s_waitcnt lgkmcnt(11)
    v_mfma_f32_16x16x32_bf16 v[64:67], v[96:99], v[128:131], v[64:67]
    ds_read2_b32 v[114:115], v44 offset0:18 offset1:19
    s_waitcnt lgkmcnt(9)
    v_mfma_f32_16x16x32_bf16 v[68:71], v[100:103], v[128:131], v[68:71]
    ds_read_b128 v[148:151], v48 offset:2624
    v_mfma_f32_16x16x32_bf16 v[72:75], v[100:103], v[132:135], v[72:75]
    ds_read2_b32 v[116:117], v45 offset0:16 offset1:17
    v_mfma_f32_16x16x32_bf16 v[68:71], v[96:99], v[132:135], v[68:71]
    ds_read2_b32 v[118:119], v45 offset0:18 offset1:19
    s_waitcnt lgkmcnt(9)
    v_mfma_f32_16x16x32_bf16 v[72:75], v[104:107], v[128:131], v[72:75]
    ds_read_b128 v[152:155], v48 offset:3136
    v_mfma_f32_16x16x32_bf16 v[76:79], v[104:107], v[132:135], v[76:79]
    ds_read2_b32 v[120:121], v46 offset0:16 offset1:17
    v_mfma_f32_16x16x32_bf16 v[80:83], v[104:107], v[136:139], v[80:83]
    ds_read2_b32 v[122:123], v46 offset0:18 offset1:19
    v_mfma_f32_16x16x32_bf16 v[72:75], v[96:99], v[136:139], v[72:75]
    ds_read_b128 v[156:159], v48 offset:3648
    v_mfma_f32_16x16x32_bf16 v[76:79], v[100:103], v[136:139], v[76:79]
    ds_read2_b32 v[124:125], v47 offset0:16 offset1:17
    s_waitcnt lgkmcnt(11)
    v_mfma_f32_16x16x32_bf16 v[76:79], v[108:111], v[128:131], v[76:79]
    ds_read2_b32 v[126:127], v47 offset0:18 offset1:19
    v_mfma_f32_16x16x32_bf16 v[80:83], v[108:111], v[132:135], v[80:83]
    ds_read_b128 v[192:195], v48 offset:0
    v_mfma_f32_16x16x32_bf16 v[84:87], v[108:111], v[136:139], v[84:87]
    ds_read2_b32 v[160:161], v40 offset0:0 offset1:1
    v_mfma_f32_16x16x32_bf16 v[88:91], v[108:111], v[140:143], v[88:91]
    ds_read2_b32 v[162:163], v40 offset0:2 offset1:3
    v_mfma_f32_16x16x32_bf16 v[76:79], v[96:99], v[140:143], v[76:79]
    v_mfma_f32_16x16x32_bf16 v[80:83], v[100:103], v[140:143], v[80:83]
    v_mfma_f32_16x16x32_bf16 v[84:87], v[104:107], v[140:143], v[84:87]
    s_waitcnt lgkmcnt(12)
    v_mfma_f32_16x16x32_bf16 v[80:83], v[112:115], v[128:131], v[80:83]
    ds_read_b128 v[196:199], v48 offset:512
    v_mfma_f32_16x16x32_bf16 v[84:87], v[112:115], v[132:135], v[84:87]
    ds_read2_b32 v[164:165], v41 offset0:0 offset1:1
    v_mfma_f32_16x16x32_bf16 v[88:91], v[112:115], v[136:139], v[88:91]
    ds_read2_b32 v[166:167], v41 offset0:2 offset1:3
    v_mfma_f32_16x16x32_bf16 v[92:95], v[112:115], v[140:143], v[92:95]
    v_mfma_f32_16x16x32_bf16 v[80:83], v[96:99], v[144:147], v[80:83]
    v_mfma_f32_16x16x32_bf16 v[84:87], v[100:103], v[144:147], v[84:87]
    v_mfma_f32_16x16x32_bf16 v[88:91], v[104:107], v[144:147], v[88:91]
    v_mfma_f32_16x16x32_bf16 v[92:95], v[108:111], v[144:147], v[92:95]
    s_waitcnt lgkmcnt(12)
    v_mfma_f32_16x16x32_bf16 v[84:87], v[116:119], v[128:131], v[84:87]
    ds_read_b128 v[200:203], v48 offset:1024
    v_mfma_f32_16x16x32_bf16 v[88:91], v[116:119], v[132:135], v[88:91]
    ds_read2_b32 v[168:169], v42 offset0:0 offset1:1
    v_mfma_f32_16x16x32_bf16 v[92:95], v[116:119], v[136:139], v[92:95]
    ds_read2_b32 v[170:171], v42 offset0:2 offset1:3
    v_mfma_f32_16x16x32_bf16 v[84:87], v[96:99], v[148:151], v[84:87]
    v_mfma_f32_16x16x32_bf16 v[88:91], v[100:103], v[148:151], v[88:91]
    v_mfma_f32_16x16x32_bf16 v[92:95], v[104:107], v[148:151], v[92:95]
    s_waitcnt lgkmcnt(12)
    v_mfma_f32_16x16x32_bf16 v[88:91], v[120:123], v[128:131], v[88:91]
    ds_read_b128 v[204:207], v48 offset:1536
    v_mfma_f32_16x16x32_bf16 v[92:95], v[120:123], v[132:135], v[92:95]
    ds_read2_b32 v[172:173], v43 offset0:0 offset1:1
    v_mfma_f32_16x16x32_bf16 v[88:91], v[96:99], v[152:155], v[88:91]
    ds_read2_b32 v[174:175], v43 offset0:2 offset1:3
    v_mfma_f32_16x16x32_bf16 v[92:95], v[100:103], v[152:155], v[92:95]
    s_waitcnt lgkmcnt(12)
    v_mfma_f32_16x16x32_bf16 v[92:95], v[124:127], v[128:131], v[92:95]
    ds_read_b128 v[208:211], v48 offset:2048
    v_mfma_f32_16x16x32_bf16 v[92:95], v[96:99], v[156:159], v[92:95]
    ds_read2_b32 v[176:177], v44 offset0:0 offset1:1
    s_waitcnt lgkmcnt(11)
    v_mfma_f32_16x16x32_bf16 v[64:67], v[160:163], v[192:195], v[64:67]
    ds_read2_b32 v[178:179], v44 offset0:2 offset1:3
    s_waitcnt lgkmcnt(9)
    v_mfma_f32_16x16x32_bf16 v[68:71], v[164:167], v[192:195], v[68:71]
    ds_read_b128 v[212:215], v48 offset:2560
    v_mfma_f32_16x16x32_bf16 v[72:75], v[164:167], v[196:199], v[72:75]
    ds_read2_b32 v[180:181], v45 offset0:0 offset1:1
    v_mfma_f32_16x16x32_bf16 v[68:71], v[160:163], v[196:199], v[68:71]
    ds_read2_b32 v[182:183], v45 offset0:2 offset1:3
    s_waitcnt lgkmcnt(9)
    v_mfma_f32_16x16x32_bf16 v[72:75], v[168:171], v[192:195], v[72:75]
    ds_read_b128 v[216:219], v48 offset:3072
    v_mfma_f32_16x16x32_bf16 v[76:79], v[168:171], v[196:199], v[76:79]
    ds_read2_b32 v[184:185], v46 offset0:0 offset1:1
    v_mfma_f32_16x16x32_bf16 v[80:83], v[168:171], v[200:203], v[80:83]
    ds_read2_b32 v[186:187], v46 offset0:2 offset1:3
    v_mfma_f32_16x16x32_bf16 v[72:75], v[160:163], v[200:203], v[72:75]
    ds_read_b128 v[220:223], v48 offset:3584
    v_mfma_f32_16x16x32_bf16 v[76:79], v[164:167], v[200:203], v[76:79]
    ds_read2_b32 v[188:189], v47 offset0:0 offset1:1
    s_waitcnt lgkmcnt(11)
    v_mfma_f32_16x16x32_bf16 v[76:79], v[172:175], v[192:195], v[76:79]
    ds_read2_b32 v[190:191], v47 offset0:2 offset1:3
    v_mfma_f32_16x16x32_bf16 v[80:83], v[172:175], v[196:199], v[80:83]
    v_mfma_f32_16x16x32_bf16 v[84:87], v[172:175], v[200:203], v[84:87]
    v_mfma_f32_16x16x32_bf16 v[88:91], v[172:175], v[204:207], v[88:91]
    v_mfma_f32_16x16x32_bf16 v[76:79], v[160:163], v[204:207], v[76:79]
    v_mfma_f32_16x16x32_bf16 v[80:83], v[164:167], v[204:207], v[80:83]
    v_mfma_f32_16x16x32_bf16 v[84:87], v[168:171], v[204:207], v[84:87]
    s_waitcnt lgkmcnt(9)
    v_mfma_f32_16x16x32_bf16 v[80:83], v[176:179], v[192:195], v[80:83]
    v_mfma_f32_16x16x32_bf16 v[84:87], v[176:179], v[196:199], v[84:87]
    v_mfma_f32_16x16x32_bf16 v[88:91], v[176:179], v[200:203], v[88:91]
    v_mfma_f32_16x16x32_bf16 v[92:95], v[176:179], v[204:207], v[92:95]
    v_mfma_f32_16x16x32_bf16 v[80:83], v[160:163], v[208:211], v[80:83]
    v_mfma_f32_16x16x32_bf16 v[84:87], v[164:167], v[208:211], v[84:87]
    v_mfma_f32_16x16x32_bf16 v[88:91], v[168:171], v[208:211], v[88:91]
    v_mfma_f32_16x16x32_bf16 v[92:95], v[172:175], v[208:211], v[92:95]
    s_waitcnt lgkmcnt(6)
    v_mfma_f32_16x16x32_bf16 v[84:87], v[180:183], v[192:195], v[84:87]
    v_mfma_f32_16x16x32_bf16 v[88:91], v[180:183], v[196:199], v[88:91]
    v_mfma_f32_16x16x32_bf16 v[92:95], v[180:183], v[200:203], v[92:95]
    v_mfma_f32_16x16x32_bf16 v[84:87], v[160:163], v[212:215], v[84:87]
    v_mfma_f32_16x16x32_bf16 v[88:91], v[164:167], v[212:215], v[88:91]
    v_mfma_f32_16x16x32_bf16 v[92:95], v[168:171], v[212:215], v[92:95]
    s_waitcnt lgkmcnt(3)
    v_mfma_f32_16x16x32_bf16 v[88:91], v[184:187], v[192:195], v[88:91]
    v_mfma_f32_16x16x32_bf16 v[92:95], v[184:187], v[196:199], v[92:95]
    v_mfma_f32_16x16x32_bf16 v[88:91], v[160:163], v[216:219], v[88:91]
    v_mfma_f32_16x16x32_bf16 v[92:95], v[164:167], v[216:219], v[92:95]
    s_waitcnt lgkmcnt(0)
    v_mfma_f32_16x16x32_bf16 v[92:95], v[188:191], v[192:195], v[92:95]
    v_mfma_f32_16x16x32_bf16 v[92:95], v[160:163], v[220:223], v[92:95]
    ds_write_b128 v49, v[64:67] offset:0
    ds_write_b128 v49, v[68:71] offset:1280
    ds_write_b128 v49, v[72:75] offset:2560
    ds_write_b128 v49, v[76:79] offset:3840
    ds_write_b128 v49, v[80:83] offset:5120
    ds_write_b128 v49, v[84:87] offset:6400
    ds_write_b128 v49, v[88:91] offset:7680
    s_nop 0
    ds_write_b128 v49, v[92:95] offset:8960
    v_lshlrev_b32 v9, 4, v240
    v_add_u32 v9, 97504, v9
    ds_read_b128 v[244:247], v9
    ds_read_b128 v[248:251], v9 offset:4608
    ds_read_b128 v[232:235], v9 offset:12832
    ds_read_b128 v[236:239], v9 offset:16928
    v_lshrrev_b32 v9, 5, v240
    v_mul_u32_u24 v9, 1280, v9
    v_and_b32 v2, 1, v240
    v_mul_u32_u24 v2, 640, v2
    v_bfe_u32 v3, v240, 1, 4
    v_lshl_add_u32 v2, v3, 4, v2
    v_add3_u32 v9, v9, v2, 0
    s_lshl_b32 s12, s97, 9
    s_add_u32 s12, s12, 7340032
    v_lshrrev_b32 v2, 4, v240
    v_lshlrev_b32 v2, 17, v2
    v_and_b32 v3, 15, v240
    v_lshl_add_u32 v2, v3, 4, v2
    v_add_u32 v2, s12, v2
    s_lshl_b32 s54, s99, 16
    s_and_b32 s55, s99, 0xffff0000
    s_lshl_b32 s58, s56, 16
    s_and_b32 s59, s56, 0xffff0000
    s_lshl_b32 s60, s52, 16
    s_and_b32 s61, s52, 0xffff0000
    v_add_u32 v3, 4290772992, v2
    s_and_b32 s100, s3, 3
    s_lshl_b32 s100, s100, 2
    s_add_u32 s100, s100, 163616
    v_mov_b32 v36, s100
    v_mov_b32 v228, 1
    s_waitcnt lgkmcnt(0)
    ds_write_b32 v36, v228
    v_mov_b32 v36, 163616
    s_mov_b32 s98, 0
GB_9:
    ds_read_b128 v[228:231], v36
    s_waitcnt lgkmcnt(0)
    v_and_b32 v228, v228, v229
    v_and_b32 v228, v228, v230
    v_and_b32 v228, v228, v231
    s_nop 0
    v_readfirstlane_b32 s100, v228
    s_add_u32 s98, s98, 1
    s_cmp_gt_u32 s98, 320000
    s_cbranch_scc1 GBD_10
    s_cmp_eq_u32 s100, 1
    s_cbranch_scc0 GB_9
GBD_10:
    ds_read_b128 v[64:67], v9 offset:0
    ds_read_b128 v[68:71], v9 offset:320
    ds_read_b128 v[72:75], v9 offset:10240
    ds_read_b128 v[76:79], v9 offset:10560
    ds_read_b128 v[80:83], v9 offset:20480
    ds_read_b128 v[84:87], v9 offset:20800
    ds_read_b128 v[88:91], v9 offset:30720
    ds_read_b128 v[92:95], v9 offset:31040
    s_waitcnt lgkmcnt(4)
    v_add_f32 v64, v64, v72
    v_add_f32 v65, v65, v73
    v_lshlrev_b32 v100, 16, v244
    v_and_b32 v101, 0xffff0000, v244
    v_cvt_pk_bf16_f32 v102, v64, v65
    v_mul_f32 v100, s54, v100
    v_mul_f32 v101, s54, v101
    v_cvt_pk_bf16_f32 v103, v100, v101
    v_lshlrev_b32 v100, 16, v102
    v_and_b32 v101, 0xffff0000, v102
    v_lshlrev_b32 v104, 16, v103
    v_and_b32 v105, 0xffff0000, v103
    v_add_f32 v100, v100, v104
    v_add_f32 v101, v101, v105
    v_cvt_pk_bf16_f32 v102, v100, v101
    v_lshlrev_b32 v100, 16, v102
    v_and_b32 v101, 0xffff0000, v102
    v_mul_f32 v100, s58, v100
    v_mul_f32 v101, s58, v101
    v_cvt_pk_bf16_f32 v102, v100, v101
    v_lshlrev_b32 v100, 16, v102
    v_and_b32 v101, 0xffff0000, v102
    v_lshlrev_b32 v104, 16, v232
    v_and_b32 v105, 0xffff0000, v232
    v_add_f32 v100, v100, v104
    v_add_f32 v101, v101, v105
    v_cvt_pk_bf16_f32 v120, v100, v101
    v_lshlrev_b32 v100, 16, v120
    v_and_b32 v101, 0xffff0000, v120
    v_mul_f32 v100, s60, v100
    v_mul_f32 v101, s60, v101
    v_cvt_pk_bf16_f32 v128, v100, v101
    v_add_f32 v66, v66, v74
    v_add_f32 v67, v67, v75
    v_lshlrev_b32 v108, 16, v245
    v_and_b32 v109, 0xffff0000, v245
    v_cvt_pk_bf16_f32 v110, v66, v67
    v_mul_f32 v108, s54, v108
    v_mul_f32 v109, s54, v109
    v_cvt_pk_bf16_f32 v111, v108, v109
    v_lshlrev_b32 v108, 16, v110
    v_and_b32 v109, 0xffff0000, v110
    v_lshlrev_b32 v112, 16, v111
    v_and_b32 v113, 0xffff0000, v111
    v_add_f32 v108, v108, v112
    v_add_f32 v109, v109, v113
    v_cvt_pk_bf16_f32 v110, v108, v109
    v_lshlrev_b32 v108, 16, v110
    v_and_b32 v109, 0xffff0000, v110
    v_mul_f32 v108, s58, v108
    v_mul_f32 v109, s58, v109
    v_cvt_pk_bf16_f32 v110, v108, v109
    v_lshlrev_b32 v108, 16, v110
    v_and_b32 v109, 0xffff0000, v110
    v_lshlrev_b32 v112, 16, v233
    v_and_b32 v113, 0xffff0000, v233
    v_add_f32 v108, v108, v112
    v_add_f32 v109, v109, v113
    v_cvt_pk_bf16_f32 v121, v108, v109
    v_lshlrev_b32 v108, 16, v121
    v_and_b32 v109, 0xffff0000, v121
    v_mul_f32 v108, s60, v108
    v_mul_f32 v109, s60, v109
    v_cvt_pk_bf16_f32 v129, v108, v109
    v_add_f32 v68, v68, v76
    v_add_f32 v69, v69, v77
    v_lshlrev_b32 v100, 16, v246
    v_and_b32 v101, 0xffff0000, v246
    v_cvt_pk_bf16_f32 v102, v68, v69
    v_mul_f32 v100, s54, v100
    v_mul_f32 v101, s54, v101
    v_cvt_pk_bf16_f32 v103, v100, v101
    v_lshlrev_b32 v100, 16, v102
    v_and_b32 v101, 0xffff0000, v102
    v_lshlrev_b32 v104, 16, v103
    v_and_b32 v105, 0xffff0000, v103
    v_add_f32 v100, v100, v104
    v_add_f32 v101, v101, v105
    v_cvt_pk_bf16_f32 v102, v100, v101
    v_lshlrev_b32 v100, 16, v102
    v_and_b32 v101, 0xffff0000, v102
    v_mul_f32 v100, s58, v100
    v_mul_f32 v101, s58, v101
    v_cvt_pk_bf16_f32 v102, v100, v101
    v_lshlrev_b32 v100, 16, v102
    v_and_b32 v101, 0xffff0000, v102
    v_lshlrev_b32 v104, 16, v234
    v_and_b32 v105, 0xffff0000, v234
    v_add_f32 v100, v100, v104
    v_add_f32 v101, v101, v105
    v_cvt_pk_bf16_f32 v122, v100, v101
    v_lshlrev_b32 v100, 16, v122
    v_and_b32 v101, 0xffff0000, v122
    v_mul_f32 v100, s60, v100
    v_mul_f32 v101, s60, v101
    v_cvt_pk_bf16_f32 v130, v100, v101
    v_add_f32 v70, v70, v78
    v_add_f32 v71, v71, v79
    v_lshlrev_b32 v108, 16, v247
    v_and_b32 v109, 0xffff0000, v247
    v_cvt_pk_bf16_f32 v110, v70, v71
    v_mul_f32 v108, s54, v108
    v_mul_f32 v109, s54, v109
    v_cvt_pk_bf16_f32 v111, v108, v109
    v_lshlrev_b32 v108, 16, v110
    v_and_b32 v109, 0xffff0000, v110
    v_lshlrev_b32 v112, 16, v111
    v_and_b32 v113, 0xffff0000, v111
    v_add_f32 v108, v108, v112
    v_add_f32 v109, v109, v113
    v_cvt_pk_bf16_f32 v110, v108, v109
    v_lshlrev_b32 v108, 16, v110
    v_and_b32 v109, 0xffff0000, v110
    v_mul_f32 v108, s58, v108
    v_mul_f32 v109, s58, v109
    v_cvt_pk_bf16_f32 v110, v108, v109
    v_lshlrev_b32 v108, 16, v110
    v_and_b32 v109, 0xffff0000, v110
    v_lshlrev_b32 v112, 16, v235
    v_and_b32 v113, 0xffff0000, v235
    v_add_f32 v108, v108, v112
    v_add_f32 v109, v109, v113
    v_cvt_pk_bf16_f32 v123, v108, v109
    v_lshlrev_b32 v108, 16, v123
    v_and_b32 v109, 0xffff0000, v123
    v_mul_f32 v108, s60, v108
    v_mul_f32 v109, s60, v109
    v_cvt_pk_bf16_f32 v131, v108, v109
    global_store_dwordx4 v3, v[128:131], s[46:47] offset:0 sc1
    global_store_dwordx4 v2, v[120:123], s[46:47] offset:0 sc1
    s_waitcnt lgkmcnt(0)
    v_add_f32 v80, v80, v88
    v_add_f32 v81, v81, v89
    v_lshlrev_b32 v100, 16, v248
    v_and_b32 v101, 0xffff0000, v248
    v_cvt_pk_bf16_f32 v102, v80, v81
    v_mul_f32 v100, s55, v100
    v_mul_f32 v101, s55, v101
    v_cvt_pk_bf16_f32 v103, v100, v101
    v_lshlrev_b32 v100, 16, v102
    v_and_b32 v101, 0xffff0000, v102
    v_lshlrev_b32 v104, 16, v103
    v_and_b32 v105, 0xffff0000, v103
    v_add_f32 v100, v100, v104
    v_add_f32 v101, v101, v105
    v_cvt_pk_bf16_f32 v102, v100, v101
    v_lshlrev_b32 v100, 16, v102
    v_and_b32 v101, 0xffff0000, v102
    v_mul_f32 v100, s59, v100
    v_mul_f32 v101, s59, v101
    v_cvt_pk_bf16_f32 v102, v100, v101
    v_lshlrev_b32 v100, 16, v102
    v_and_b32 v101, 0xffff0000, v102
    v_lshlrev_b32 v104, 16, v236
    v_and_b32 v105, 0xffff0000, v236
    v_add_f32 v100, v100, v104
    v_add_f32 v101, v101, v105
    v_cvt_pk_bf16_f32 v124, v100, v101
    v_lshlrev_b32 v100, 16, v124
    v_and_b32 v101, 0xffff0000, v124
    v_mul_f32 v100, s61, v100
    v_mul_f32 v101, s61, v101
    v_cvt_pk_bf16_f32 v132, v100, v101
    v_add_f32 v82, v82, v90
    v_add_f32 v83, v83, v91
    v_lshlrev_b32 v108, 16, v249
    v_and_b32 v109, 0xffff0000, v249
    v_cvt_pk_bf16_f32 v110, v82, v83
    v_mul_f32 v108, s55, v108
    v_mul_f32 v109, s55, v109
    v_cvt_pk_bf16_f32 v111, v108, v109
    v_lshlrev_b32 v108, 16, v110
    v_and_b32 v109, 0xffff0000, v110
    v_lshlrev_b32 v112, 16, v111
    v_and_b32 v113, 0xffff0000, v111
    v_add_f32 v108, v108, v112
    v_add_f32 v109, v109, v113
    v_cvt_pk_bf16_f32 v110, v108, v109
    v_lshlrev_b32 v108, 16, v110
    v_and_b32 v109, 0xffff0000, v110
    v_mul_f32 v108, s59, v108
    v_mul_f32 v109, s59, v109
    v_cvt_pk_bf16_f32 v110, v108, v109
    v_lshlrev_b32 v108, 16, v110
    v_and_b32 v109, 0xffff0000, v110
    v_lshlrev_b32 v112, 16, v237
    v_and_b32 v113, 0xffff0000, v237
    v_add_f32 v108, v108, v112
    v_add_f32 v109, v109, v113
    v_cvt_pk_bf16_f32 v125, v108, v109
    v_lshlrev_b32 v108, 16, v125
    v_and_b32 v109, 0xffff0000, v125
    v_mul_f32 v108, s61, v108
    v_mul_f32 v109, s61, v109
    v_cvt_pk_bf16_f32 v133, v108, v109
    v_add_f32 v84, v84, v92
    v_add_f32 v85, v85, v93
    v_lshlrev_b32 v100, 16, v250
    v_and_b32 v101, 0xffff0000, v250
    v_cvt_pk_bf16_f32 v102, v84, v85
    v_mul_f32 v100, s55, v100
    v_mul_f32 v101, s55, v101
    v_cvt_pk_bf16_f32 v103, v100, v101
    v_lshlrev_b32 v100, 16, v102
    v_and_b32 v101, 0xffff0000, v102
    v_lshlrev_b32 v104, 16, v103
    v_and_b32 v105, 0xffff0000, v103
    v_add_f32 v100, v100, v104
    v_add_f32 v101, v101, v105
    v_cvt_pk_bf16_f32 v102, v100, v101
    v_lshlrev_b32 v100, 16, v102
    v_and_b32 v101, 0xffff0000, v102
    v_mul_f32 v100, s59, v100
    v_mul_f32 v101, s59, v101
    v_cvt_pk_bf16_f32 v102, v100, v101
    v_lshlrev_b32 v100, 16, v102
    v_and_b32 v101, 0xffff0000, v102
    v_lshlrev_b32 v104, 16, v238
    v_and_b32 v105, 0xffff0000, v238
    v_add_f32 v100, v100, v104
    v_add_f32 v101, v101, v105
    v_cvt_pk_bf16_f32 v126, v100, v101
    v_lshlrev_b32 v100, 16, v126
    v_and_b32 v101, 0xffff0000, v126
    v_mul_f32 v100, s61, v100
    v_mul_f32 v101, s61, v101
    v_cvt_pk_bf16_f32 v134, v100, v101
    v_add_f32 v86, v86, v94
    v_add_f32 v87, v87, v95
    v_lshlrev_b32 v108, 16, v251
    v_and_b32 v109, 0xffff0000, v251
    v_cvt_pk_bf16_f32 v110, v86, v87
    v_mul_f32 v108, s55, v108
    v_mul_f32 v109, s55, v109
    v_cvt_pk_bf16_f32 v111, v108, v109
    v_lshlrev_b32 v108, 16, v110
    v_and_b32 v109, 0xffff0000, v110
    v_lshlrev_b32 v112, 16, v111
    v_and_b32 v113, 0xffff0000, v111
    v_add_f32 v108, v108, v112
    v_add_f32 v109, v109, v113
    v_cvt_pk_bf16_f32 v110, v108, v109
    v_lshlrev_b32 v108, 16, v110
    v_and_b32 v109, 0xffff0000, v110
    v_mul_f32 v108, s59, v108
    v_mul_f32 v109, s59, v109
    v_cvt_pk_bf16_f32 v110, v108, v109
    v_lshlrev_b32 v108, 16, v110
    v_and_b32 v109, 0xffff0000, v110
    v_lshlrev_b32 v112, 16, v239
    v_and_b32 v113, 0xffff0000, v239
    v_add_f32 v108, v108, v112
    v_add_f32 v109, v109, v113
    v_cvt_pk_bf16_f32 v127, v108, v109
    v_lshlrev_b32 v108, 16, v127
    v_and_b32 v109, 0xffff0000, v127
    v_mul_f32 v108, s61, v108
    v_mul_f32 v109, s61, v109
    v_cvt_pk_bf16_f32 v135, v108, v109
    global_store_dwordx4 v3, v[132:135], s[46:47] offset:256 sc1
    global_store_dwordx4 v2, v[124:127], s[46:47] offset:256 sc1
.L_PADEND:
    s_waitcnt vmcnt(0)
    s_branch P2_END
AUX:
    s_sub_u32 s4, s3, 4
    s_mul_i32 s5, s2, 2341
    s_lshr_b32 s5, s5, 16
    s_mul_i32 s6, s5, 28
    s_sub_u32 s6, s2, s6
    s_cmp_ge_u32 s6, 14
    s_cselect_b32 s7, 1, 0
    s_mul_i32 s8, s7, 14
    s_sub_u32 s8, s6, s8
    s_lshl_b32 s9, s5, 2
    s_add_u32 s9, s9, s4
    s_cmp_ge_u32 s3, 6
    s_cbranch_scc1 AUX_mod
    s_lshl_b32 s14, s2, 13
    s_lshl_b32 s15, s4, 12
    s_add_u32 s14, s14, s15
    v_lshlrev_b32 v3, 4, v0
    v_add_u32 v3, s14, v3
    global_load_dwordx4 v[16:19], v3, s[16:17] offset:0
    global_load_dwordx4 v[20:23], v3, s[16:17] offset:1024
    global_load_dwordx4 v[24:27], v3, s[16:17] offset:2048
    global_load_dwordx4 v[28:31], v3, s[16:17] offset:3072
    s_mul_i32 s14, s4, 4160
    s_add_u32 s14, s14, 118528
    v_lshlrev_b32 v4, 4, v0
    v_add_u32 v4, s14, v4
    s_lshl_b32 s14, s4, 9
    s_add_u32 s14, s14, 118528
    v_and_b32 v5, 3, v0
    v_mul_u32_u24 v5, 2080, v5
    v_and_b32 v6, 60, v0
    v_add3_u32 v7, v5, v6, s14
    s_barrier
    s_mov_b32 s15, 0x3f803f80
    v_mov_b32 v40, 0
    v_mov_b32 v41, 0
    v_mov_b32 v42, 0
    v_mov_b32 v43, 0
    v_mov_b32 v44, 0
    v_mov_b32 v45, 0
    v_mov_b32 v46, 0
    v_mov_b32 v47, 0
    s_waitcnt vmcnt(0) lgkmcnt(0)
    s_add_u32 s96, s96, 1
    ds_write_b128 v4, v[16:19] offset:0
    ds_write_b128 v4, v[20:23] offset:1040
    ds_write_b128 v4, v[24:27] offset:2080
    ds_write_b128 v4, v[28:31] offset:3120
    s_and_b32 s100, s3, 3
    s_lshl_b32 s100, s100, 2
    s_add_u32 s100, s100, 163664
    v_mov_b32 v36, s100
    v_mov_b32 v96, 1
    s_waitcnt lgkmcnt(0)
    ds_write_b32 v36, v96
    v_dot2_f32_bf16 v40, v16, s15, v40
    v_dot2_f32_bf16 v41, v16, v16, v41
    v_dot2_f32_bf16 v42, v20, s15, v42
    v_dot2_f32_bf16 v43, v20, v20, v43
    v_dot2_f32_bf16 v44, v24, s15, v44
    v_dot2_f32_bf16 v45, v24, v24, v45
    v_dot2_f32_bf16 v46, v28, s15, v46
    v_dot2_f32_bf16 v47, v28, v28, v47
    v_dot2_f32_bf16 v40, v17, s15, v40
    v_dot2_f32_bf16 v41, v17, v17, v41
    v_dot2_f32_bf16 v42, v21, s15, v42
    v_dot2_f32_bf16 v43, v21, v21, v43
    v_dot2_f32_bf16 v44, v25, s15, v44
    v_dot2_f32_bf16 v45, v25, v25, v45
    v_dot2_f32_bf16 v46, v29, s15, v46
    v_dot2_f32_bf16 v47, v29, v29, v47
    v_dot2_f32_bf16 v40, v18, s15, v40
    v_dot2_f32_bf16 v41, v18, v18, v41
    v_dot2_f32_bf16 v42, v22, s15, v42
    v_dot2_f32_bf16 v43, v22, v22, v43
    v_dot2_f32_bf16 v44, v26, s15, v44
    v_dot2_f32_bf16 v45, v26, v26, v45
    v_dot2_f32_bf16 v46, v30, s15, v46
    v_dot2_f32_bf16 v47, v30, v30, v47
    v_dot2_f32_bf16 v40, v19, s15, v40
    v_dot2_f32_bf16 v41, v19, v19, v41
    v_dot2_f32_bf16 v42, v23, s15, v42
    v_dot2_f32_bf16 v43, v23, v23, v43
    v_dot2_f32_bf16 v44, v27, s15, v44
    v_dot2_f32_bf16 v45, v27, v27, v45
    v_dot2_f32_bf16 v46, v31, s15, v46
    v_dot2_f32_bf16 v47, v31, v31, v47
    v_add_f32 v40, v40, v40 row_shr:1 bound_ctrl:0
    v_add_f32 v41, v41, v41 row_shr:1 bound_ctrl:0
    v_add_f32 v42, v42, v42 row_shr:1 bound_ctrl:0
    v_add_f32 v43, v43, v43 row_shr:1 bound_ctrl:0
    v_add_f32 v44, v44, v44 row_shr:1 bound_ctrl:0
    v_add_f32 v45, v45, v45 row_shr:1 bound_ctrl:0
    v_add_f32 v46, v46, v46 row_shr:1 bound_ctrl:0
    v_add_f32 v47, v47, v47 row_shr:1 bound_ctrl:0
    v_add_f32 v40, v40, v40 row_shr:2 bound_ctrl:0
    v_add_f32 v41, v41, v41 row_shr:2 bound_ctrl:0
    v_add_f32 v42, v42, v42 row_shr:2 bound_ctrl:0
    v_add_f32 v43, v43, v43 row_shr:2 bound_ctrl:0
    v_add_f32 v44, v44, v44 row_shr:2 bound_ctrl:0
    v_add_f32 v45, v45, v45 row_shr:2 bound_ctrl:0
    v_add_f32 v46, v46, v46 row_shr:2 bound_ctrl:0
    v_add_f32 v47, v47, v47 row_shr:2 bound_ctrl:0
    v_add_f32 v40, v40, v40 row_shr:4 bound_ctrl:0
    v_add_f32 v41, v41, v41 row_shr:4 bound_ctrl:0
    v_add_f32 v42, v42, v42 row_shr:4 bound_ctrl:0
    v_add_f32 v43, v43, v43 row_shr:4 bound_ctrl:0
    v_add_f32 v44, v44, v44 row_shr:4 bound_ctrl:0
    v_add_f32 v45, v45, v45 row_shr:4 bound_ctrl:0
    v_add_f32 v46, v46, v46 row_shr:4 bound_ctrl:0
    v_add_f32 v47, v47, v47 row_shr:4 bound_ctrl:0
    v_add_f32 v40, v40, v40 row_shr:8 bound_ctrl:0
    v_add_f32 v41, v41, v41 row_shr:8 bound_ctrl:0
    v_add_f32 v42, v42, v42 row_shr:8 bound_ctrl:0
    v_add_f32 v43, v43, v43 row_shr:8 bound_ctrl:0
    v_add_f32 v44, v44, v44 row_shr:8 bound_ctrl:0
    v_add_f32 v45, v45, v45 row_shr:8 bound_ctrl:0
    v_add_f32 v46, v46, v46 row_shr:8 bound_ctrl:0
    v_add_f32 v47, v47, v47 row_shr:8 bound_ctrl:0
    v_add_f32 v40, v40, v40 row_bcast:15 row_mask:0xa
    v_add_f32 v41, v41, v41 row_bcast:15 row_mask:0xa
    v_add_f32 v42, v42, v42 row_bcast:15 row_mask:0xa
    v_add_f32 v43, v43, v43 row_bcast:15 row_mask:0xa
    v_add_f32 v44, v44, v44 row_bcast:15 row_mask:0xa
    v_add_f32 v45, v45, v45 row_bcast:15 row_mask:0xa
    v_add_f32 v46, v46, v46 row_bcast:15 row_mask:0xa
    v_add_f32 v47, v47, v47 row_bcast:15 row_mask:0xa
    v_add_f32 v40, v40, v40 row_bcast:31 row_mask:0xc
    v_add_f32 v41, v41, v41 row_bcast:31 row_mask:0xc
    v_add_f32 v42, v42, v42 row_bcast:31 row_mask:0xc
    v_add_f32 v43, v43, v43 row_bcast:31 row_mask:0xc
    v_add_f32 v44, v44, v44 row_bcast:31 row_mask:0xc
    v_add_f32 v45, v45, v45 row_bcast:31 row_mask:0xc
    v_add_f32 v46, v46, v46 row_bcast:31 row_mask:0xc
    v_add_f32 v47, v47, v47 row_bcast:31 row_mask:0xc
    v_and_b32 v36, 0xfffffff8, v36
    s_mov_b32 s98, 0
GB_11:
    ds_read_b64 v[96:97], v36
    s_waitcnt lgkmcnt(0)
    v_and_b32 v96, v96, v97
    s_nop 0
    v_readfirstlane_b32 s100, v96
    s_add_u32 s98, s98, 1
    s_cmp_gt_u32 s98, 320000
    s_cbranch_scc1 GBD_12
    s_cmp_eq_u32 s100, 1
    s_cbranch_scc0 GB_11
GBD_12:
    ds_read_b32 v64, v7 offset:0
    ds_read_b32 v66, v7 offset:1040
    ds_read_b32 v68, v7 offset:64
    ds_read_b32 v70, v7 offset:1104
    ds_read_b32 v72, v7 offset:128
    ds_read_b32 v74, v7 offset:1168
    ds_read_b32 v76, v7 offset:192
    ds_read_b32 v78, v7 offset:1232
    ds_read_b32 v80, v7 offset:256
    ds_read_b32 v82, v7 offset:1296
    ds_read_b32 v84, v7 offset:320
    ds_read_b32 v86, v7 offset:1360
    ds_read_b32 v88, v7 offset:384
    ds_read_b32 v90, v7 offset:1424
    ds_read_b32 v92, v7 offset:448
    ds_read_b32 v94, v7 offset:1488
    v_mul_f32 v40, 0x3b000000, v40
    v_mul_f32 v41, 0x3b000000, v41
    v_fma_f32 v41, -v40, v40, v41
    v_max_f32 v41, 0, v41
    v_cvt_pk_bf16_f32 v41, v41, v41
    v_lshlrev_b32 v41, 16, v41
    v_add_f32 v41, 0x3727c5ac, v41
    v_cvt_pk_bf16_f32 v41, v41, v41
    v_lshlrev_b32 v41, 16, v41
    v_sqrt_f32 v41, v41
    s_nop 0
    v_cvt_pk_bf16_f32 v48, v40, v41
    v_mul_f32 v42, 0x3b000000, v42
    v_mul_f32 v43, 0x3b000000, v43
    v_fma_f32 v43, -v42, v42, v43
    v_max_f32 v43, 0, v43
    v_cvt_pk_bf16_f32 v43, v43, v43
    v_lshlrev_b32 v43, 16, v43
    v_add_f32 v43, 0x3727c5ac, v43
    v_cvt_pk_bf16_f32 v43, v43, v43
    v_lshlrev_b32 v43, 16, v43
    v_sqrt_f32 v43, v43
    s_nop 0
    v_cvt_pk_bf16_f32 v50, v42, v43
    v_mul_f32 v44, 0x3b000000, v44
    v_mul_f32 v45, 0x3b000000, v45
    v_fma_f32 v45, -v44, v44, v45
    v_max_f32 v45, 0, v45
    v_cvt_pk_bf16_f32 v45, v45, v45
    v_lshlrev_b32 v45, 16, v45
    v_add_f32 v45, 0x3727c5ac, v45
    v_cvt_pk_bf16_f32 v45, v45, v45
    v_lshlrev_b32 v45, 16, v45
    v_sqrt_f32 v45, v45
    s_nop 0
    v_cvt_pk_bf16_f32 v52, v44, v45
    v_mul_f32 v46, 0x3b000000, v46
    v_mul_f32 v47, 0x3b000000, v47
    v_fma_f32 v47, -v46, v46, v47
    v_max_f32 v47, 0, v47
    v_cvt_pk_bf16_f32 v47, v47, v47
    v_lshlrev_b32 v47, 16, v47
    v_add_f32 v47, 0x3727c5ac, v47
    v_cvt_pk_bf16_f32 v47, v47, v47
    v_lshlrev_b32 v47, 16, v47
    v_sqrt_f32 v47, v47
    s_nop 0
    v_cvt_pk_bf16_f32 v54, v46, v47
    v_mov_b32 v49, s96
    v_mov_b32 v51, s96
    v_mov_b32 v53, s96
    v_mov_b32 v55, s96
    s_lshl_b32 s14, s2, 6
    s_lshl_b32 s15, s4, 5
    s_add_u32 s14, s14, s15
    v_mov_b32 v5, s14
    s_mov_b64 exec, 0
    s_bitset1_b64 exec, 63
    global_store_dwordx4 v5, v[48:51], s[46:47] offset:0 sc1
    global_store_dwordx4 v5, v[52:55], s[46:47] offset:16 sc1
    s_mov_b64 exec, -1
    s_lshl_b32 s14, s2, 14
    s_lshl_b32 s15, s4, 13
    s_add_u32 s14, s14, s15
    s_add_u32 s14, s14, 16777216
    v_lshlrev_b32 v5, 4, v0
    v_add_u32 v5, s14, v5
    v_add_u32 v6, 4096, v5
    s_waitcnt lgkmcnt(0)
    v_mov_b32 v65, s96
    v_mov_b32 v67, s96
    global_store_dwordx4 v5, v[64:67], s[46:47] offset:0 sc1
    v_mov_b32 v69, s96
    v_mov_b32 v71, s96
    global_store_dwordx4 v5, v[68:71], s[46:47] offset:1024 sc1
    v_mov_b32 v73, s96
    v_mov_b32 v75, s96
    global_store_dwordx4 v5, v[72:75], s[46:47] offset:2048 sc1
    v_mov_b32 v77, s96
    v_mov_b32 v79, s96
    global_store_dwordx4 v5, v[76:79], s[46:47] offset:3072 sc1
    v_mov_b32 v81, s96
    v_mov_b32 v83, s96
    global_store_dwordx4 v6, v[80:83], s[46:47] offset:0 sc1
    v_mov_b32 v85, s96
    v_mov_b32 v87, s96
    global_store_dwordx4 v6, v[84:87], s[46:47] offset:1024 sc1
    v_mov_b32 v89, s96
    v_mov_b32 v91, s96
    global_store_dwordx4 v6, v[88:91], s[46:47] offset:2048 sc1
    v_mov_b32 v93, s96
    v_mov_b32 v95, s96
    global_store_dwordx4 v6, v[92:95], s[46:47] offset:3072 sc1
    s_branch AUX_p1done
AUX_mod:
    s_cmp_ge_u32 s2, 192
    s_cbranch_scc1 AUX_nomod
    s_lshl_b32 s14, s2, 1
    s_add_u32 s14, s14, s3
    s_sub_u32 s14, s14, 6
    s_mul_i32 s15, s14, 2731
    s_lshr_b32 s15, s15, 16
    s_mul_i32 s48, s15, 24
    s_sub_u32 s14, s14, s48
    s_mul_i32 s48, s15, 196608
    s_lshl_b32 s49, s14, 8
    s_add_u32 s48, s48, s49
    v_lshrrev_b32 v5, 4, v0
    v_and_b32 v6, 15, v0
    v_mul_u32_u24 v1, 49152, v5
    v_lshl_add_u32 v1, v6, 4, v1
    v_add_u32 v1, s48, v1
    v_lshlrev_b32 v2, 4, v5
    s_lshl_b32 s48, s15, 6
    v_add_u32 v2, s48, v2
    global_load_dwordx4 v[8:11], v2, s[38:39]
    global_load_dwordx4 v[16:19], v1, s[40:41]
    v_add_u32 v1, 0x1800, v1
    global_load_dwordx4 v[20:23], v1, s[40:41]
    v_add_u32 v1, 0x1800, v1
    global_load_dwordx4 v[24:27], v1, s[40:41]
    v_add_u32 v1, 0x1800, v1
    global_load_dwordx4 v[28:31], v1, s[40:41]
    v_add_u32 v1, 0x1800, v1
    global_load_dwordx4 v[32:35], v1, s[40:41]
    v_add_u32 v1, 0x1800, v1
    global_load_dwordx4 v[36:39], v1, s[40:41]
    v_add_u32 v1, 0x1800, v1
    global_load_dwordx4 v[40:43], v1, s[40:41]
    v_add_u32 v1, 0x1800, v1
    global_load_dwordx4 v[44:47], v1, s[40:41]
    s_mul_i32 s48, s15, 24576
    s_lshl_b32 s49, s14, 10
    s_add_u32 s48, s48, s49
    s_add_u32 s48, s48, 524288
    v_lshlrev_b32 v2, 6, v6
    v_lshl_add_u32 v2, v5, 4, v2
    v_add_u32 v2, s48, v2
    s_barrier
    s_waitcnt vmcnt(8) lgkmcnt(0)
    s_add_u32 s96, s96, 1
    v_lshlrev_b32 v56, 16, v8
    v_and_b32 v57, 0xffff0000, v8
    v_lshlrev_b32 v58, 16, v9
    v_and_b32 v59, 0xffff0000, v9
    v_lshlrev_b32 v60, 16, v10
    v_and_b32 v61, 0xffff0000, v10
    v_lshlrev_b32 v62, 16, v11
    v_and_b32 v63, 0xffff0000, v11
    v_mul_f32 v64, 0xbfb8aa3b, v56
    v_mul_f32 v65, 0xbfb8aa3b, v57
    v_mul_f32 v66, 0xbfb8aa3b, v58
    v_mul_f32 v67, 0xbfb8aa3b, v59
    v_mul_f32 v68, 0xbfb8aa3b, v60
    v_mul_f32 v69, 0xbfb8aa3b, v61
    v_mul_f32 v70, 0xbfb8aa3b, v62
    v_mul_f32 v71, 0xbfb8aa3b, v63
    v_exp_f32 v64, v64
    v_exp_f32 v65, v65
    v_exp_f32 v66, v66
    v_exp_f32 v67, v67
    v_exp_f32 v68, v68
    v_exp_f32 v69, v69
    v_exp_f32 v70, v70
    v_exp_f32 v71, v71
    v_add_f32 v64, 1.0, v64
    v_add_f32 v65, 1.0, v65
    v_add_f32 v66, 1.0, v66
    v_add_f32 v67, 1.0, v67
    v_add_f32 v68, 1.0, v68
    v_add_f32 v69, 1.0, v69
    v_add_f32 v70, 1.0, v70
    v_add_f32 v71, 1.0, v71
    v_rcp_f32 v64, v64
    v_rcp_f32 v65, v65
    v_rcp_f32 v66, v66
    v_rcp_f32 v67, v67
    v_rcp_f32 v68, v68
    v_rcp_f32 v69, v69
    v_rcp_f32 v70, v70
    v_rcp_f32 v71, v71
    v_mul_f32 v56, v56, v64
    v_mul_f32 v57, v57, v65
    v_mul_f32 v58, v58, v66
    v_mul_f32 v59, v59, v67
    v_mul_f32 v60, v60, v68
    v_mul_f32 v61, v61, v69
    v_mul_f32 v62, v62, v70
    v_mul_f32 v63, v63, v71
    v_cvt_pk_bf16_f32 v64, v56, v57
    v_lshlrev_b32 v56, 16, v64
    v_and_b32 v57, 0xffff0000, v64
    v_cvt_pk_bf16_f32 v64, v58, v59
    v_lshlrev_b32 v58, 16, v64
    v_and_b32 v59, 0xffff0000, v64
    v_cvt_pk_bf16_f32 v64, v60, v61
    v_lshlrev_b32 v60, 16, v64
    v_and_b32 v61, 0xffff0000, v64
    v_cvt_pk_bf16_f32 v64, v62, v63
    v_lshlrev_b32 v62, 16, v64
    v_and_b32 v63, 0xffff0000, v64
    s_waitcnt vmcnt(7)
    v_lshlrev_b32 v64, 16, v16
    v_and_b32 v65, 0xffff0000, v16
    v_mul_f32 v72, v56, v64
    v_mul_f32 v73, v56, v65
    v_lshlrev_b32 v66, 16, v17
    v_and_b32 v67, 0xffff0000, v17
    v_mul_f32 v74, v56, v66
    v_mul_f32 v75, v56, v67
    v_lshlrev_b32 v64, 16, v18
    v_and_b32 v65, 0xffff0000, v18
    v_mul_f32 v76, v56, v64
    v_mul_f32 v77, v56, v65
    v_lshlrev_b32 v66, 16, v19
    v_and_b32 v67, 0xffff0000, v19
    v_mul_f32 v78, v56, v66
    v_mul_f32 v79, v56, v67
    s_waitcnt vmcnt(6)
    v_lshlrev_b32 v64, 16, v20
    v_and_b32 v65, 0xffff0000, v20
    v_fmac_f32 v72, v57, v64
    v_fmac_f32 v73, v57, v65
    v_lshlrev_b32 v66, 16, v21
    v_and_b32 v67, 0xffff0000, v21
    v_fmac_f32 v74, v57, v66
    v_fmac_f32 v75, v57, v67
    v_lshlrev_b32 v64, 16, v22
    v_and_b32 v65, 0xffff0000, v22
    v_fmac_f32 v76, v57, v64
    v_fmac_f32 v77, v57, v65
    v_lshlrev_b32 v66, 16, v23
    v_and_b32 v67, 0xffff0000, v23
    v_fmac_f32 v78, v57, v66
    v_fmac_f32 v79, v57, v67
    s_waitcnt vmcnt(5)
    v_lshlrev_b32 v64, 16, v24
    v_and_b32 v65, 0xffff0000, v24
    v_fmac_f32 v72, v58, v64
    v_fmac_f32 v73, v58, v65
    v_lshlrev_b32 v66, 16, v25
    v_and_b32 v67, 0xffff0000, v25
    v_fmac_f32 v74, v58, v66
    v_fmac_f32 v75, v58, v67
    v_lshlrev_b32 v64, 16, v26
    v_and_b32 v65, 0xffff0000, v26
    v_fmac_f32 v76, v58, v64
    v_fmac_f32 v77, v58, v65
    v_lshlrev_b32 v66, 16, v27
    v_and_b32 v67, 0xffff0000, v27
    v_fmac_f32 v78, v58, v66
    v_fmac_f32 v79, v58, v67
    s_waitcnt vmcnt(4)
    v_lshlrev_b32 v64, 16, v28
    v_and_b32 v65, 0xffff0000, v28
    v_fmac_f32 v72, v59, v64
    v_fmac_f32 v73, v59, v65
    v_lshlrev_b32 v66, 16, v29
    v_and_b32 v67, 0xffff0000, v29
    v_fmac_f32 v74, v59, v66
    v_fmac_f32 v75, v59, v67
    v_lshlrev_b32 v64, 16, v30
    v_and_b32 v65, 0xffff0000, v30
    v_fmac_f32 v76, v59, v64
    v_fmac_f32 v77, v59, v65
    v_lshlrev_b32 v66, 16, v31
    v_and_b32 v67, 0xffff0000, v31
    v_fmac_f32 v78, v59, v66
    v_fmac_f32 v79, v59, v67
    s_waitcnt vmcnt(3)
    v_lshlrev_b32 v64, 16, v32
    v_and_b32 v65, 0xffff0000, v32
    v_fmac_f32 v72, v60, v64
    v_fmac_f32 v73, v60, v65
    v_lshlrev_b32 v66, 16, v33
    v_and_b32 v67, 0xffff0000, v33
    v_fmac_f32 v74, v60, v66
    v_fmac_f32 v75, v60, v67
    v_lshlrev_b32 v64, 16, v34
    v_and_b32 v65, 0xffff0000, v34
    v_fmac_f32 v76, v60, v64
    v_fmac_f32 v77, v60, v65
    v_lshlrev_b32 v66, 16, v35
    v_and_b32 v67, 0xffff0000, v35
    v_fmac_f32 v78, v60, v66
    v_fmac_f32 v79, v60, v67
    s_waitcnt vmcnt(2)
    v_lshlrev_b32 v64, 16, v36
    v_and_b32 v65, 0xffff0000, v36
    v_fmac_f32 v72, v61, v64
    v_fmac_f32 v73, v61, v65
    v_lshlrev_b32 v66, 16, v37
    v_and_b32 v67, 0xffff0000, v37
    v_fmac_f32 v74, v61, v66
    v_fmac_f32 v75, v61, v67
    v_lshlrev_b32 v64, 16, v38
    v_and_b32 v65, 0xffff0000, v38
    v_fmac_f32 v76, v61, v64
    v_fmac_f32 v77, v61, v65
    v_lshlrev_b32 v66, 16, v39
    v_and_b32 v67, 0xffff0000, v39
    v_fmac_f32 v78, v61, v66
    v_fmac_f32 v79, v61, v67
    s_waitcnt vmcnt(1)
    v_lshlrev_b32 v64, 16, v40
    v_and_b32 v65, 0xffff0000, v40
    v_fmac_f32 v72, v62, v64
    v_fmac_f32 v73, v62, v65
    v_lshlrev_b32 v66, 16, v41
    v_and_b32 v67, 0xffff0000, v41
    v_fmac_f32 v74, v62, v66
    v_fmac_f32 v75, v62, v67
    v_lshlrev_b32 v64, 16, v42
    v_and_b32 v65, 0xffff0000, v42
    v_fmac_f32 v76, v62, v64
    v_fmac_f32 v77, v62, v65
    v_lshlrev_b32 v66, 16, v43
    v_and_b32 v67, 0xffff0000, v43
    v_fmac_f32 v78, v62, v66
    v_fmac_f32 v79, v62, v67
    s_waitcnt vmcnt(0)
    v_lshlrev_b32 v64, 16, v44
    v_and_b32 v65, 0xffff0000, v44
    v_fmac_f32 v72, v63, v64
    v_fmac_f32 v73, v63, v65
    v_lshlrev_b32 v66, 16, v45
    v_and_b32 v67, 0xffff0000, v45
    v_fmac_f32 v74, v63, v66
    v_fmac_f32 v75, v63, v67
    v_lshlrev_b32 v64, 16, v46
    v_and_b32 v65, 0xffff0000, v46
    v_fmac_f32 v76, v63, v64
    v_fmac_f32 v77, v63, v65
    v_lshlrev_b32 v66, 16, v47
    v_and_b32 v67, 0xffff0000, v47
    v_fmac_f32 v78, v63, v66
    v_fmac_f32 v79, v63, v67
    v_permlane32_swap_b32 v72, v76
    v_permlane32_swap_b32 v73, v77
    v_permlane32_swap_b32 v74, v78
    v_permlane32_swap_b32 v75, v79
    v_add_f32 v72, v72, v76
    v_add_f32 v73, v73, v77
    v_add_f32 v74, v74, v78
    v_add_f32 v75, v75, v79
    s_nop 0
    v_permlane16_swap_b32 v72, v74
    v_permlane16_swap_b32 v73, v75
    v_add_f32 v48, v72, v74
    v_add_f32 v50, v73, v75
    v_mov_b32 v49, s96
    v_mov_b32 v51, s96
    global_store_dwordx4 v2, v[48:51], s[46:47] sc1
    s_branch AUX_p1done
AUX_nomod:
    s_barrier
    s_waitcnt lgkmcnt(0)
    s_add_u32 s96, s96, 1
AUX_p1done:
    v_mov_b32 v1, 163680
    s_mov_b32 s98, 0
GB_13:
    s_sleep 4
    ds_read_b128 v[4:7], v1
    s_waitcnt lgkmcnt(0)
    v_and_b32 v4, v4, v5
    v_and_b32 v4, v4, v6
    v_and_b32 v4, v4, v7
    s_nop 0
    v_readfirstlane_b32 s100, v4
    s_add_u32 s98, s98, 1
    s_cmp_gt_u32 s98, 320000
    s_cbranch_scc1 GBD_14
    s_cmp_eq_u32 s100, 1
    s_cbranch_scc0 GB_13
GBD_14:
    s_cmp_ge_u32 s2, 224
    s_cbranch_scc1 NOW_15
    s_mul_i32 s10, s9, 57344
    s_lshl_b32 s11, s8, 8
    s_add_u32 s10, s10, s11
    v_lshrrev_b32 v101, 4, v0
    v_and_b32 v102, 15, v0
    v_lshlrev_b32 v100, 2, v101
    v_xor_b32 v100, v100, v102
    v_lshlrev_b32 v100, 4, v100
    v_mul_u32_u24 v101, 3584, v101
    v_add3_u32 v100, v100, v101, s10
    s_cmp_eq_u32 s7, 0
    s_cselect_b32 s12, s32, s34
    s_cselect_b32 s13, s33, s35
    s_lshl_b32 s14, s2, 2
    s_add_u32 s14, s14, s4
    s_lshr_b32 s15, s14, 3
    s_min_u32 s15, s15, 111
    s_and_b32 s14, s14, 7
    s_lshl_b32 s48, s15, 14
    s_lshl_b32 s49, s14, 7
    s_add_u32 s48, s48, s49
    v_lshrrev_b32 v140, 3, v0
    v_lshlrev_b32 v140, 10, v140
    v_and_b32 v141, 7, v0
    v_lshl_add_u32 v140, v141, 4, v140
    v_add_u32 v140, s48, v140
    s_mul_i32 s49, s4, 6144
    s_add_u32 s49, s49, 40960
    s_mov_b32 m0, s49
    s_add_u32 s49, s49, 1024
    global_load_lds_dwordx4 v100, s[12:13]
    v_add_u32 v100, 14336, v100
    s_mov_b32 m0, s49
    s_add_u32 s49, s49, 1024
    global_load_lds_dwordx4 v100, s[12:13]
    v_add_u32 v100, 14336, v100
    s_mov_b32 m0, s49
    s_add_u32 s49, s49, 1024
    global_load_lds_dwordx4 v100, s[12:13]
    v_add_u32 v100, 14336, v100
    s_mov_b32 m0, s49
    s_add_u32 s49, s49, 1024
    global_load_lds_dwordx4 v100, s[12:13]
    s_mov_b32 m0, s49
    s_add_u32 s49, s49, 1024
    global_load_lds_dwordx4 v140, s[36:37]
    v_add_u32 v140, 8192, v140
    s_mov_b32 m0, s49
    s_add_u32 s49, s49, 1024
    global_load_lds_dwordx4 v140, s[36:37]
NOW_15:
    s_lshl_b32 s14, s2, 2
    s_add_u32 s14, s14, s4
    s_lshr_b32 s15, s14, 3
    s_and_b32 s14, s14, 7
    v_lshrrev_b32 v152, 5, v0
    s_lshl_b32 s48, s14, 1
    v_add_u32 v152, s48, v152
    v_mul_u32_u24 v152, 112, v152
    v_add_u32 v152, s15, v152
    v_lshlrev_b32 v152, 10, v152
    v_and_b32 v142, 31, v0
    v_lshl_add_u32 v152, v142, 4, v152
    v_add_u32 v152, 1048576, v152
    s_cmp_ge_u32 s2, 224
    s_cbranch_scc1 AUX_noprep
    v_and_b32 v4, 15, v0
    v_lshrrev_b32 v5, 4, v0
    v_mul_u32_u24 v6, 24576, v4
    v_lshlrev_b32 v7, 5, v5
    s_lshl_b32 s10, s9, 7
    s_add_u32 s10, s10, 536576
    v_add3_u32 v6, v6, v7, s10
    v_add_u32 v7, 4096, v6
    global_load_dwordx4 v[8:11], v6, s[46:47] sc1
    global_load_dwordx4 v[12:15], v6, s[46:47] offset:16 sc1
    global_load_dwordx4 v[16:19], v7, s[46:47] sc1
    global_load_dwordx4 v[20:23], v7, s[46:47] offset:16 sc1
    s_cmp_ge_u32 s2, 224
    s_cbranch_scc1 NOG_16
    s_and_b32 s62, s2, 7
    s_lshr_b32 s63, s2, 3
    s_mul_i32 s60, s63, 37
    s_lshr_b32 s60, s60, 8
    s_mul_i32 s61, s60, 7
    s_sub_u32 s61, s63, s61
    s_lshr_b32 s63, s62, 1
    s_lshl_b32 s63, s63, 2
    s_add_u32 s60, s60, s63
    s_and_b32 s62, s62, 1
    s_mul_i32 s62, s62, 7
    s_add_u32 s61, s61, s62
    v_lshrrev_b32 v162, 4, v0
    v_lshlrev_b32 v160, 2, v162
    v_and_b32 v161, 15, v0
    v_xor_b32 v160, v160, v161
    v_xor_b32 v161, 2, v160
    v_mul_u32_u24 v162, 3584, v162
    s_lshl_b32 s62, s61, 8
    v_add_u32 v162, s62, v162
    v_lshl_add_u32 v160, v160, 4, v162
    v_lshl_add_u32 v161, v161, 4, v162
    s_mul_i32 s62, s4, 57344
    v_add_u32 v162, s62, v160
    v_add_u32 v163, s62, v161
    s_lshl_b32 s63, s4, 12
    s_add_u32 s63, s63, 130048
    s_mov_b32 m0, s63
    s_add_u32 s62, s63, 16384
    global_load_lds_dwordx4 v162, s[32:33]
    s_mov_b32 m0, s62
    s_add_u32 s63, s63, 1024
    global_load_lds_dwordx4 v163, s[34:35]
    v_add_u32 v162, 14336, v162
    v_add_u32 v163, 14336, v163
    s_mov_b32 m0, s63
    s_add_u32 s62, s63, 16384
    global_load_lds_dwordx4 v162, s[32:33]
    s_mov_b32 m0, s62
    s_add_u32 s63, s63, 1024
    global_load_lds_dwordx4 v163, s[34:35]
    v_add_u32 v162, 14336, v162
    v_add_u32 v163, 14336, v163
    s_mov_b32 m0, s63
    s_add_u32 s62, s63, 16384
    global_load_lds_dwordx4 v162, s[32:33]
    s_mov_b32 m0, s62
    s_add_u32 s63, s63, 1024
    global_load_lds_dwordx4 v163, s[34:35]
    v_add_u32 v162, 14336, v162
    v_add_u32 v163, 14336, v163
    s_mov_b32 m0, s63
    s_add_u32 s62, s63, 16384
    global_load_lds_dwordx4 v162, s[32:33]
    s_mov_b32 m0, s62
    s_add_u32 s63, s63, 1024
    global_load_lds_dwordx4 v163, s[34:35]
NOG_16:
    s_waitcnt vmcnt(8)
    s_mov_b32 s98, 0
    s_branch POLN_20
POL_17:
    global_load_dwordx4 v[8:11], v6, s[46:47] sc1
    global_load_dwordx4 v[12:15], v6, s[46:47] offset:16 sc1
    global_load_dwordx4 v[16:19], v7, s[46:47] sc1
    global_load_dwordx4 v[20:23], v7, s[46:47] offset:16 sc1
POLM_19:
    s_mov_b64 exec, -1
    s_waitcnt vmcnt(0)
POLN_20:
    v_cmp_ne_u32 vcc, s96, v9
    v_cmp_ne_u32 s[100:101], s96, v11
    s_nop 1
    s_or_b64 vcc, vcc, s[100:101]
    v_cmp_ne_u32 s[100:101], s96, v13
    s_nop 1
    s_or_b64 vcc, vcc, s[100:101]
    v_cmp_ne_u32 s[100:101], s96, v15
    s_nop 1
    s_or_b64 vcc, vcc, s[100:101]
    v_cmp_ne_u32 s[100:101], s96, v17
    s_nop 1
    s_or_b64 vcc, vcc, s[100:101]
    v_cmp_ne_u32 s[100:101], s96, v19
    s_nop 1
    s_or_b64 vcc, vcc, s[100:101]
    v_cmp_ne_u32 s[100:101], s96, v21
    s_nop 1
    s_or_b64 vcc, vcc, s[100:101]
    v_cmp_ne_u32 s[100:101], s96, v23
    s_nop 1
    s_or_b64 vcc, vcc, s[100:101]
    s_add_u32 s98, s98, 1
    s_cmp_gt_u32 s98, 40000
    s_cbranch_scc1 POLD_18
    s_cmp_eq_u64 vcc, 0
    s_cbranch_scc1 POLD_18
    s_mov_b64 exec, vcc
    s_sleep 16
    s_branch POL_17
POLD_18:
    s_mul_i32 s14, s4, 6144
    s_add_u32 s14, s14, 40960
    v_lshrrev_b32 v25, 2, v4
    v_and_b32 v26, 3, v4
    v_lshlrev_b32 v27, 1, v5
    v_lshrrev_b32 v28, 1, v26
    v_add_u32 v27, v27, v28
    v_and_b32 v28, 1, v26
    v_lshlrev_b32 v28, 3, v28
    v_lshl_add_u32 v29, v27, 4, v28
    v_lshl_add_u32 v29, v25, 7, v29
    v_add_u32 v29, s14, v29
    v_lshlrev_b32 v30, 2, v25
    v_xor_b32 v27, v27, v30
    v_lshl_add_u32 v27, v27, 4, v28
    v_lshl_add_u32 v27, v25, 8, v27
    v_add_u32 v27, s14, v27
    v_subrev_u32 v28, s14, v27
    v_xor_b32 v28, 128, v28
    v_add_u32 v28, s14, v28
    ds_read_b64_tr_b16 v[144:145], v29 offset:4096
    ds_read_b64_tr_b16 v[146:147], v29 offset:5120
    ds_read_b64_tr_b16 v[148:149], v29 offset:4608
    ds_read_b64_tr_b16 v[150:151], v29 offset:5632
    ds_read_b64_tr_b16 v[104:105], v27 offset:0
    ds_read_b64_tr_b16 v[120:121], v28 offset:0
    ds_read_b64_tr_b16 v[106:107], v27 offset:1024
    ds_read_b64_tr_b16 v[122:123], v28 offset:1024
    ds_read_b64_tr_b16 v[108:109], v27 offset:2048
    ds_read_b64_tr_b16 v[124:125], v28 offset:2048
    ds_read_b64_tr_b16 v[110:111], v27 offset:3072
    ds_read_b64_tr_b16 v[126:127], v28 offset:3072
    s_waitcnt lgkmcnt(8)
    global_store_dwordx4 v152, v[144:147], s[46:47] sc1
    global_store_dwordx4 v152, v[148:151], s[46:47] offset:512 sc1
    v_lshrrev_b32 v2, 4, v0
    s_lshl_b32 s14, s8, 3
    v_add_u32 v2, s14, v2
    v_and_b32 v3, 15, v0
    s_lshl_b32 s14, s7, 4
    v_add_u32 v3, s14, v3
    v_lshl_add_u32 v7, v2, 5, v3
    v_add_f32 v8, v8, v8 row_shr:1 bound_ctrl:0
    v_add_f32 v10, v10, v10 row_shr:1 bound_ctrl:0
    v_add_f32 v12, v12, v12 row_shr:1 bound_ctrl:0
    v_add_f32 v14, v14, v14 row_shr:1 bound_ctrl:0
    v_add_f32 v16, v16, v16 row_shr:1 bound_ctrl:0
    v_add_f32 v18, v18, v18 row_shr:1 bound_ctrl:0
    v_add_f32 v20, v20, v20 row_shr:1 bound_ctrl:0
    v_add_f32 v22, v22, v22 row_shr:1 bound_ctrl:0
    v_add_f32 v8, v8, v8 row_shr:2 bound_ctrl:0
    v_add_f32 v10, v10, v10 row_shr:2 bound_ctrl:0
    v_add_f32 v12, v12, v12 row_shr:2 bound_ctrl:0
    v_add_f32 v14, v14, v14 row_shr:2 bound_ctrl:0
    v_add_f32 v16, v16, v16 row_shr:2 bound_ctrl:0
    v_add_f32 v18, v18, v18 row_shr:2 bound_ctrl:0
    v_add_f32 v20, v20, v20 row_shr:2 bound_ctrl:0
    v_add_f32 v22, v22, v22 row_shr:2 bound_ctrl:0
    v_add_f32 v8, v8, v8 row_shr:4 bound_ctrl:0
    v_add_f32 v10, v10, v10 row_shr:4 bound_ctrl:0
    v_add_f32 v12, v12, v12 row_shr:4 bound_ctrl:0
    v_add_f32 v14, v14, v14 row_shr:4 bound_ctrl:0
    v_add_f32 v16, v16, v16 row_shr:4 bound_ctrl:0
    v_add_f32 v18, v18, v18 row_shr:4 bound_ctrl:0
    v_add_f32 v20, v20, v20 row_shr:4 bound_ctrl:0
    v_add_f32 v22, v22, v22 row_shr:4 bound_ctrl:0
    v_add_f32 v8, v8, v8 row_shr:8 bound_ctrl:0
    v_add_f32 v10, v10, v10 row_shr:8 bound_ctrl:0
    v_add_f32 v12, v12, v12 row_shr:8 bound_ctrl:0
    v_add_f32 v14, v14, v14 row_shr:8 bound_ctrl:0
    v_add_f32 v16, v16, v16 row_shr:8 bound_ctrl:0
    v_add_f32 v18, v18, v18 row_shr:8 bound_ctrl:0
    v_add_f32 v20, v20, v20 row_shr:8 bound_ctrl:0
    v_add_f32 v22, v22, v22 row_shr:8 bound_ctrl:0
    v_cvt_pk_bf16_f32 v8, v8, v8
    v_lshlrev_b32 v8, 16, v8
    v_cvt_pk_bf16_f32 v10, v10, v10
    v_lshlrev_b32 v10, 16, v10
    v_cvt_pk_bf16_f32 v12, v12, v12
    v_lshlrev_b32 v12, 16, v12
    v_cvt_pk_bf16_f32 v14, v14, v14
    v_lshlrev_b32 v14, 16, v14
    v_cvt_pk_bf16_f32 v16, v16, v16
    v_lshlrev_b32 v16, 16, v16
    v_cvt_pk_bf16_f32 v18, v18, v18
    v_lshlrev_b32 v18, 16, v18
    v_cvt_pk_bf16_f32 v20, v20, v20
    v_lshlrev_b32 v20, 16, v20
    v_cvt_pk_bf16_f32 v22, v22, v22
    v_lshlrev_b32 v22, 16, v22
    v_add_f32 v16, 1.0, v16
    v_cvt_pk_bf16_f32 v16, v16, v16
    v_lshlrev_b32 v16, 16, v16
    v_add_f32 v18, 1.0, v18
    v_cvt_pk_bf16_f32 v18, v18, v18
    v_lshlrev_b32 v18, 16, v18
    v_add_f32 v20, 1.0, v20
    v_cvt_pk_bf16_f32 v20, v20, v20
    v_lshlrev_b32 v20, 16, v20
    v_add_f32 v22, 1.0, v22
    v_cvt_pk_bf16_f32 v22, v22, v22
    v_lshlrev_b32 v22, 16, v22
    v_readlane_b32 s48, v8, 15
    v_readlane_b32 s49, v10, 15
    v_readlane_b32 s50, v12, 15
    v_readlane_b32 s51, v14, 15
    v_readlane_b32 s52, v8, 31
    v_readlane_b32 s53, v10, 31
    v_readlane_b32 s54, v12, 31
    v_readlane_b32 s55, v14, 31
    v_readlane_b32 s56, v8, 47
    v_readlane_b32 s57, v10, 47
    v_readlane_b32 s58, v12, 47
    v_readlane_b32 s59, v14, 47
    v_readlane_b32 s60, v8, 63
    v_readlane_b32 s61, v10, 63
    v_readlane_b32 s62, v12, 63
    v_readlane_b32 s63, v14, 63
    v_readlane_b32 s64, v16, 15
    v_readlane_b32 s65, v18, 15
    v_readlane_b32 s66, v20, 15
    v_readlane_b32 s67, v22, 15
    v_readlane_b32 s68, v16, 31
    v_readlane_b32 s69, v18, 31
    v_readlane_b32 s70, v20, 31
    v_readlane_b32 s71, v22, 31
    v_readlane_b32 s72, v16, 47
    v_readlane_b32 s73, v18, 47
    v_readlane_b32 s74, v20, 47
    v_readlane_b32 s75, v22, 47
    v_readlane_b32 s76, v16, 63
    v_readlane_b32 s77, v18, 63
    v_readlane_b32 s78, v20, 63
    v_readlane_b32 s79, v22, 63
    s_mov_b32 s15, 0x3f803f80
    v_mov_b32 v60, 0
    v_mov_b32 v61, 0
    v_mov_b32 v62, 0
    v_mov_b32 v63, 0
    s_waitcnt lgkmcnt(0)
    v_lshlrev_b32 v32, 16, v104
    v_lshlrev_b32 v33, 16, v120
    v_and_b32 v34, 0xffff0000, v104
    v_and_b32 v35, 0xffff0000, v120
    v_fmac_f32 v62, s48, v32
    v_fmac_f32 v63, s48, v33
    v_fmac_f32 v60, s64, v32
    v_fmac_f32 v61, s64, v33
    v_fmac_f32 v62, s49, v34
    v_fmac_f32 v63, s49, v35
    v_fmac_f32 v60, s65, v34
    v_fmac_f32 v61, s65, v35
    v_lshlrev_b32 v32, 16, v105
    v_lshlrev_b32 v33, 16, v121
    v_and_b32 v34, 0xffff0000, v105
    v_and_b32 v35, 0xffff0000, v121
    v_fmac_f32 v62, s50, v32
    v_fmac_f32 v63, s50, v33
    v_fmac_f32 v60, s66, v32
    v_fmac_f32 v61, s66, v33
    v_fmac_f32 v62, s51, v34
    v_fmac_f32 v63, s51, v35
    v_fmac_f32 v60, s67, v34
    v_fmac_f32 v61, s67, v35
    v_lshlrev_b32 v32, 16, v106
    v_lshlrev_b32 v33, 16, v122
    v_and_b32 v34, 0xffff0000, v106
    v_and_b32 v35, 0xffff0000, v122
    v_fmac_f32 v62, s52, v32
    v_fmac_f32 v63, s52, v33
    v_fmac_f32 v60, s68, v32
    v_fmac_f32 v61, s68, v33
    v_fmac_f32 v62, s53, v34
    v_fmac_f32 v63, s53, v35
    v_fmac_f32 v60, s69, v34
    v_fmac_f32 v61, s69, v35
    v_lshlrev_b32 v32, 16, v107
    v_lshlrev_b32 v33, 16, v123
    v_and_b32 v34, 0xffff0000, v107
    v_and_b32 v35, 0xffff0000, v123
    v_fmac_f32 v62, s54, v32
    v_fmac_f32 v63, s54, v33
    v_fmac_f32 v60, s70, v32
    v_fmac_f32 v61, s70, v33
    v_fmac_f32 v62, s55, v34
    v_fmac_f32 v63, s55, v35
    v_fmac_f32 v60, s71, v34
    v_fmac_f32 v61, s71, v35
    v_lshlrev_b32 v32, 16, v108
    v_lshlrev_b32 v33, 16, v124
    v_and_b32 v34, 0xffff0000, v108
    v_and_b32 v35, 0xffff0000, v124
    v_fmac_f32 v62, s56, v32
    v_fmac_f32 v63, s56, v33
    v_fmac_f32 v60, s72, v32
    v_fmac_f32 v61, s72, v33
    v_fmac_f32 v62, s57, v34
    v_fmac_f32 v63, s57, v35
    v_fmac_f32 v60, s73, v34
    v_fmac_f32 v61, s73, v35
    v_lshlrev_b32 v32, 16, v109
    v_lshlrev_b32 v33, 16, v125
    v_and_b32 v34, 0xffff0000, v109
    v_and_b32 v35, 0xffff0000, v125
    v_fmac_f32 v62, s58, v32
    v_fmac_f32 v63, s58, v33
    v_fmac_f32 v60, s74, v32
    v_fmac_f32 v61, s74, v33
    v_fmac_f32 v62, s59, v34
    v_fmac_f32 v63, s59, v35
    v_fmac_f32 v60, s75, v34
    v_fmac_f32 v61, s75, v35
    v_lshlrev_b32 v32, 16, v110
    v_lshlrev_b32 v33, 16, v126
    v_and_b32 v34, 0xffff0000, v110
    v_and_b32 v35, 0xffff0000, v126
    v_fmac_f32 v62, s60, v32
    v_fmac_f32 v63, s60, v33
    v_fmac_f32 v60, s76, v32
    v_fmac_f32 v61, s76, v33
    v_fmac_f32 v62, s61, v34
    v_fmac_f32 v63, s61, v35
    v_fmac_f32 v60, s77, v34
    v_fmac_f32 v61, s77, v35
    v_lshlrev_b32 v32, 16, v111
    v_lshlrev_b32 v33, 16, v127
    v_and_b32 v34, 0xffff0000, v111
    v_and_b32 v35, 0xffff0000, v127
    v_fmac_f32 v62, s62, v32
    v_fmac_f32 v63, s62, v33
    v_fmac_f32 v60, s78, v32
    v_fmac_f32 v61, s78, v33
    v_fmac_f32 v62, s63, v34
    v_fmac_f32 v63, s63, v35
    v_fmac_f32 v60, s79, v34
    v_fmac_f32 v61, s79, v35
    s_sub_u32 s4, s3, 4
    s_lshl_b32 s14, s4, 10
    s_add_u32 s14, s14, 106240
    v_lshlrev_b32 v1, 4, v0
    v_add_u32 v2, s14, v1
    ds_write_b128 v2, v[60:63]
    s_cmp_eq_u32 s4, 0
    s_cbranch_scc1 AUX_w4
    s_and_b32 s100, s3, 3
    s_lshl_b32 s100, s100, 2
    s_add_u32 s100, s100, 163632
    v_mov_b32 v36, s100
    v_mov_b32 v96, 1
    s_waitcnt lgkmcnt(0)
    ds_write_b32 v36, v96
    v_add_u32 v162, 186368, v162
    v_add_u32 v163, 186368, v163
    global_load_dwordx4 v[64:67], v162, s[32:33]
    global_load_dwordx4 v[68:71], v163, s[34:35]
    v_add_u32 v162, 14336, v162
    v_add_u32 v163, 14336, v163
    global_load_dwordx4 v[72:75], v162, s[32:33]
    global_load_dwordx4 v[76:79], v163, s[34:35]
    v_add_u32 v162, 14336, v162
    v_add_u32 v163, 14336, v163
    global_load_dwordx4 v[80:83], v162, s[32:33]
    global_load_dwordx4 v[84:87], v163, s[34:35]
    v_add_u32 v162, 14336, v162
    v_add_u32 v163, 14336, v163
    global_load_dwordx4 v[88:91], v162, s[32:33]
    global_load_dwordx4 v[92:95], v163, s[34:35]
    v_add_u32 v162, 186368, v162
    v_add_u32 v163, 186368, v163
    global_load_dwordx4 v[168:171], v162, s[32:33]
    global_load_dwordx4 v[172:175], v163, s[34:35]
    v_add_u32 v162, 14336, v162
    v_add_u32 v163, 14336, v163
    global_load_dwordx4 v[176:179], v162, s[32:33]
    global_load_dwordx4 v[180:183], v163, s[34:35]
    v_add_u32 v162, 14336, v162
    v_add_u32 v163, 14336, v163
    global_load_dwordx4 v[184:187], v162, s[32:33]
    global_load_dwordx4 v[188:191], v163, s[34:35]
    v_add_u32 v162, 14336, v162
    v_add_u32 v163, 14336, v163
    global_load_dwordx4 v[192:195], v162, s[32:33]
    global_load_dwordx4 v[196:199], v163, s[34:35]
    v_add_u32 v162, 186368, v162
    v_add_u32 v163, 186368, v163
    global_load_dwordx4 v[200:203], v162, s[32:33]
    global_load_dwordx4 v[204:207], v163, s[34:35]
    v_add_u32 v162, 14336, v162
    v_add_u32 v163, 14336, v163
    global_load_dwordx4 v[208:211], v162, s[32:33]
    global_load_dwordx4 v[212:215], v163, s[34:35]
    v_add_u32 v162, 14336, v162
    v_add_u32 v163, 14336, v163
    global_load_dwordx4 v[216:219], v162, s[32:33]
    global_load_dwordx4 v[220:223], v163, s[34:35]
    v_add_u32 v162, 14336, v162
    v_add_u32 v163, 14336, v163
    global_load_dwordx4 v[224:227], v162, s[32:33]
    global_load_dwordx4 v[228:231], v163, s[34:35]
    v_add_u32 v162, 186368, v162
    v_add_u32 v163, 186368, v163
    global_load_dwordx4 v[232:235], v162, s[32:33]
    global_load_dwordx4 v[236:239], v163, s[34:35]
    v_add_u32 v162, 14336, v162
    v_add_u32 v163, 14336, v163
    global_load_dwordx4 v[240:243], v162, s[32:33]
    global_load_dwordx4 v[244:247], v163, s[34:35]
    v_add_u32 v162, 14336, v162
    v_add_u32 v163, 14336, v163
    global_load_dwordx4 v[248:251], v162, s[32:33]
    global_load_dwordx4 v[252:255], v163, s[34:35]
    v_add_u32 v162, 14336, v162
    v_add_u32 v163, 14336, v163
    global_load_dwordx4 v[128:131], v162, s[32:33]
    global_load_dwordx4 v[132:135], v163, s[34:35]
    s_waitcnt vmcnt(32)
    s_branch P2_END
AUX_w4:
    s_and_b32 s100, s3, 3
    s_lshl_b32 s100, s100, 2
    s_add_u32 s100, s100, 163632
    v_mov_b32 v36, s100
    v_mov_b32 v96, 1
    s_waitcnt lgkmcnt(0)
    ds_write_b32 v36, v96
    v_mov_b32 v36, 163632
    s_mov_b32 s98, 0
GB_21:
    ds_read_b128 v[96:99], v36
    s_waitcnt lgkmcnt(0)
    v_and_b32 v96, v96, v97
    v_and_b32 v96, v96, v98
    v_and_b32 v96, v96, v99
    s_nop 0
    v_readfirstlane_b32 s100, v96
    s_add_u32 s98, s98, 1
    s_cmp_gt_u32 s98, 320000
    s_cbranch_scc1 GBD_22
    s_cmp_eq_u32 s100, 1
    s_cbranch_scc0 GB_21
GBD_22:
    v_add_u32 v1, 106240, v1
    ds_read_b128 v[8:11], v1
    ds_read_b128 v[12:15], v1 offset:1024
    ds_read_b128 v[16:19], v1 offset:2048
    ds_read_b128 v[20:23], v1 offset:3072
    s_mul_i32 s14, s5, 28672
    s_add_u32 s14, s14, 131072
    v_lshlrev_b32 v7, 2, v7
    v_add_u32 v7, s14, v7
    v_add_u32 v6, 14336, v7
    s_waitcnt lgkmcnt(0)
    v_add_f32 v8, v8, v12
    v_add_f32 v16, v16, v20
    v_add_f32 v9, v9, v13
    v_add_f32 v17, v17, v21
    v_add_f32 v10, v10, v14
    v_add_f32 v18, v18, v22
    v_add_f32 v11, v11, v15
    v_add_f32 v19, v19, v23
    v_add_f32 v8, v8, v16
    v_add_f32 v9, v9, v17
    v_add_f32 v10, v10, v18
    v_add_f32 v11, v11, v19
    global_store_dword v7, v8, s[46:47] sc1
    global_store_dword v7, v9, s[46:47] offset:512 sc1
    global_store_dword v6, v10, s[46:47] sc1
    global_store_dword v6, v11, s[46:47] offset:512 sc1
    v_add_u32 v162, 186368, v162
    v_add_u32 v163, 186368, v163
    global_load_dwordx4 v[64:67], v162, s[32:33]
    global_load_dwordx4 v[68:71], v163, s[34:35]
    v_add_u32 v162, 14336, v162
    v_add_u32 v163, 14336, v163
    global_load_dwordx4 v[72:75], v162, s[32:33]
    global_load_dwordx4 v[76:79], v163, s[34:35]
    v_add_u32 v162, 14336, v162
    v_add_u32 v163, 14336, v163
    global_load_dwordx4 v[80:83], v162, s[32:33]
    global_load_dwordx4 v[84:87], v163, s[34:35]
    v_add_u32 v162, 14336, v162
    v_add_u32 v163, 14336, v163
    global_load_dwordx4 v[88:91], v162, s[32:33]
    global_load_dwordx4 v[92:95], v163, s[34:35]
    v_add_u32 v162, 186368, v162
    v_add_u32 v163, 186368, v163
    global_load_dwordx4 v[168:171], v162, s[32:33]
    global_load_dwordx4 v[172:175], v163, s[34:35]
    v_add_u32 v162, 14336, v162
    v_add_u32 v163, 14336, v163
    global_load_dwordx4 v[176:179], v162, s[32:33]
    global_load_dwordx4 v[180:183], v163, s[34:35]
    v_add_u32 v162, 14336, v162
    v_add_u32 v163, 14336, v163
    global_load_dwordx4 v[184:187], v162, s[32:33]
    global_load_dwordx4 v[188:191], v163, s[34:35]
    v_add_u32 v162, 14336, v162
    v_add_u32 v163, 14336, v163
    global_load_dwordx4 v[192:195], v162, s[32:33]
    global_load_dwordx4 v[196:199], v163, s[34:35]
    v_add_u32 v162, 186368, v162
    v_add_u32 v163, 186368, v163
    global_load_dwordx4 v[200:203], v162, s[32:33]
    global_load_dwordx4 v[204:207], v163, s[34:35]
    v_add_u32 v162, 14336, v162
    v_add_u32 v163, 14336, v163
    global_load_dwordx4 v[208:211], v162, s[32:33]
    global_load_dwordx4 v[212:215], v163, s[34:35]
    v_add_u32 v162, 14336, v162
    v_add_u32 v163, 14336, v163
    global_load_dwordx4 v[216:219], v162, s[32:33]
    global_load_dwordx4 v[220:223], v163, s[34:35]
    v_add_u32 v162, 14336, v162
    v_add_u32 v163, 14336, v163
    global_load_dwordx4 v[224:227], v162, s[32:33]
    global_load_dwordx4 v[228:231], v163, s[34:35]
    v_add_u32 v162, 186368, v162
    v_add_u32 v163, 186368, v163
    global_load_dwordx4 v[232:235], v162, s[32:33]
    global_load_dwordx4 v[236:239], v163, s[34:35]
    v_add_u32 v162, 14336, v162
    v_add_u32 v163, 14336, v163
    global_load_dwordx4 v[240:243], v162, s[32:33]
    global_load_dwordx4 v[244:247], v163, s[34:35]
    v_add_u32 v162, 14336, v162
    v_add_u32 v163, 14336, v163
    global_load_dwordx4 v[248:251], v162, s[32:33]
    global_load_dwordx4 v[252:255], v163, s[34:35]
    v_add_u32 v162, 14336, v162
    v_add_u32 v163, 14336, v163
    global_load_dwordx4 v[128:131], v162, s[32:33]
    global_load_dwordx4 v[132:135], v163, s[34:35]
    s_waitcnt vmcnt(32)
    s_branch P2_END
AUX_noprep:
    s_waitcnt vmcnt(0)
P2_END:
    s_and_b32 s4, s2, 7
    s_lshr_b32 s5, s2, 3
    s_lshr_b32 s10, s5, 3
    s_lshl_b32 s6, s4, 2
    s_add_u32 s10, s10, s6
    s_and_b32 s11, s5, 7
    s_lshl_b32 s6, s10, 1
    s_add_u32 s6, s6, s11
    s_add_u32 s6, s6, s3
    s_and_b32 s99, s6, 7
    s_mul_i32 s6, s99, 14336
    s_mul_i32 s7, s11, 229376
    s_add_u32 s7, s7, s6
    s_add_u32 s7, s7, 1048576
    v_lshlrev_b32 v28, 4, v0
    v_add_u32 v30, s7, v28
    v_add_u32 v31, 114688, v30
    s_mul_i32 s6, s5, 37
    s_lshr_b32 s6, s6, 8
    s_mul_i32 s7, s6, 7
    s_sub_u32 s7, s5, s7
    s_lshr_b32 s8, s4, 1
    s_lshl_b32 s8, s8, 2
    s_add_u32 s8, s8, s6
    s_and_b32 s9, s4, 1
    s_mul_i32 s9, s9, 7
    s_add_u32 s7, s9, s7
    s_lshl_b32 s9, s7, 3
    s_and_b32 s6, s3, 6
    s_add_u32 s9, s9, s6
    s_sub_u32 s4, s3, 4
    s_lshl_b32 s4, s4, 12
    v_add_u32 v29, s4, v28
    s_barrier
    s_cmp_eq_u32 s3, 7
    s_cbranch_scc0 SB_nf
    s_lshl_b32 s4, s2, 6
    s_add_u32 s4, s4, 32768
    v_mov_b32 v1, s4
    v_mov_b32 v2, s96
    s_mov_b64 exec, 1
    global_store_dword v1, v2, s[46:47] sc1
    s_mov_b64 exec, -1
SB_nf:
    s_cmp_ge_u32 s3, 4
    s_cbranch_scc0 SB_n7
    s_cmp_ge_u32 s2, 224
    s_cbranch_scc1 SB_nw
    s_waitcnt vmcnt(0)
    v_add_u32 v28, 49152, v29
    ds_write_b128 v28, v[64:67] offset:0
    ds_write_b128 v28, v[68:71] offset:16384
    ds_write_b128 v28, v[72:75] offset:1024
    ds_write_b128 v28, v[76:79] offset:17408
    ds_write_b128 v28, v[80:83] offset:2048
    ds_write_b128 v28, v[84:87] offset:18432
    ds_write_b128 v28, v[88:91] offset:3072
    ds_write_b128 v28, v[92:95] offset:19456
    v_add_u32 v28, 81920, v29
    ds_write_b128 v28, v[168:171] offset:0
    ds_write_b128 v28, v[172:175] offset:16384
    ds_write_b128 v28, v[176:179] offset:1024
    ds_write_b128 v28, v[180:183] offset:17408
    ds_write_b128 v28, v[184:187] offset:2048
    ds_write_b128 v28, v[188:191] offset:18432
    ds_write_b128 v28, v[192:195] offset:3072
    ds_write_b128 v28, v[196:199] offset:19456
SB_nw:
    s_cmp_eq_u32 s3, 7
    s_cbranch_scc0 SB_n7
    v_lshlrev_b32 v3, 8, v0
    v_add_u32 v3, 32768, v3
    s_mov_b32 s98, 0
POL_23:
    global_load_dword v4, v3, s[46:47] offset:0 sc1
    global_load_dword v5, v3, s[46:47] offset:64 sc1
    global_load_dword v6, v3, s[46:47] offset:128 sc1
    global_load_dword v7, v3, s[46:47] offset:192 sc1
POLM_25:
    s_mov_b64 exec, -1
    s_waitcnt vmcnt(0)
POLN_26:
    v_cmp_ne_u32 vcc, s96, v4
    v_cmp_ne_u32 s[100:101], s96, v5
    s_nop 1
    s_or_b64 vcc, vcc, s[100:101]
    v_cmp_ne_u32 s[100:101], s96, v6
    s_nop 1
    s_or_b64 vcc, vcc, s[100:101]
    v_cmp_ne_u32 s[100:101], s96, v7
    s_nop 1
    s_or_b64 vcc, vcc, s[100:101]
    s_add_u32 s98, s98, 1
    s_cmp_gt_u32 s98, 40000
    s_cbranch_scc1 POLD_24
    s_cmp_eq_u64 vcc, 0
    s_cbranch_scc1 POLD_24
    s_mov_b64 exec, vcc
    s_sleep 2
    s_branch POL_23
POLD_24:
SB_n7:
    s_waitcnt lgkmcnt(0)
    s_barrier
    s_add_u32 s4, s2, s3
    s_cmp_eq_u32 s4, 0
    s_cbranch_scc0 NOEPOCH
    v_mov_b32 v1, 126976
    v_mov_b32 v2, s96
    s_mov_b64 exec, 1
    global_store_dword v1, v2, s[46:47] sc1
    s_mov_b64 exec, -1
NOEPOCH:
    s_cmp_ge_u32 s2, 224
    s_cbranch_scc1 STATS_WG
    v_lshrrev_b32 v1, 4, v0
    v_and_b32 v2, 15, v0
    v_lshlrev_b32 v3, 2, v1
    v_xor_b32 v3, v3, v2
    v_lshlrev_b32 v3, 4, v3
    v_lshl_add_u32 v3, v1, 8, v3
    s_lshl_b32 s6, s8, 17
    v_add_u32 v3, s6, v3
    v_lshlrev_b32 v4, 4, v0
    s_add_u32 s12, s46, 0x300000
    s_addc_u32 s13, s47, 0
    s_mov_b32 s14, 0x200000
    s_mov_b32 s15, 0x00020000
    s_mov_b32 s52, s32
    s_mov_b32 s53, s33
    s_mov_b32 s54, 1835008
    s_mov_b32 s55, 0x00020000
    s_mov_b32 s56, s34
    s_mov_b32 s57, s35
    s_mov_b32 s58, 1835008
    s_mov_b32 s59, 0x00020000
    s_lshl_b32 s48, s3, 11
    s_mul_i32 s49, s3, 28672
    s_mov_b32 s61, s7
    v_lshrrev_b32 v24, 4, v0
    v_lshlrev_b32 v5, 2, v24
    v_and_b32 v6, 15, v0
    v_xor_b32 v5, v5, v6
    v_xor_b32 v6, 2, v5
    v_mul_u32_u24 v24, 3584, v24
    s_lshl_b32 s62, s61, 8
    v_add_u32 v24, s62, v24
    v_lshl_add_u32 v5, v5, 4, v24
    v_lshl_add_u32 v6, v6, 4, v24
    s_add_u32 s50, s48, 0
    s_mov_b32 m0, s50
    s_add_u32 s51, s48, 0
    buffer_load_dwordx4 v3, s[12:15], s51 offen sc1 lds
    s_add_u32 s50, s48, 1024
    s_mov_b32 m0, s50
    s_add_u32 s51, s48, 1024
    buffer_load_dwordx4 v3, s[12:15], s51 offen sc1 lds
    s_add_u32 s50, s48, 16384
    s_mov_b32 m0, s50
    s_add_u32 s51, s48, 16384
    buffer_load_dwordx4 v3, s[12:15], s51 offen sc1 lds
    s_add_u32 s50, s48, 17408
    s_mov_b32 m0, s50
    s_add_u32 s51, s48, 17408
    buffer_load_dwordx4 v3, s[12:15], s51 offen sc1 lds
    s_add_u32 s50, s48, 32768
    s_mov_b32 m0, s50
    s_add_u32 s51, s48, 32768
    buffer_load_dwordx4 v3, s[12:15], s51 offen sc1 lds
    s_add_u32 s50, s48, 33792
    s_mov_b32 m0, s50
    s_add_u32 s51, s48, 33792
    buffer_load_dwordx4 v3, s[12:15], s51 offen sc1 lds
    v_lshrrev_b32 v25, 5, v0
    v_mul_u32_u24 v25, 28672, v25
    v_and_b32 v7, 31, v0
    v_lshl_add_u32 v25, v7, 3, v25
    s_lshl_b32 s50, s9, 8
    s_add_u32 s50, s50, 393216
    v_add_u32 v25, s50, v25
    v_lshrrev_b32 v12, 2, v2
    v_and_b32 v13, 3, v2
    v_lshrrev_b32 v14, 1, v1
    v_lshl_add_u32 v14, v14, 3, v12
    v_lshlrev_b32 v14, 8, v14
    v_and_b32 v15, 1, v1
    v_lshl_add_u32 v26, v15, 5, v14
    v_lshl_add_u32 v26, v13, 3, v26
    s_and_b32 s50, s3, 1
    s_lshl_b32 s50, s50, 1
    s_add_u32 s51, s50, 0
    v_xor_b32 v27, s51, v12
    v_lshl_add_u32 v8, v27, 6, v26
    s_add_u32 s51, s50, 1
    v_xor_b32 v27, s51, v12
    v_lshl_add_u32 v9, v27, 6, v26
    v_lshrrev_b32 v26, 1, v13
    s_and_b32 s50, s3, 6
    s_lshl_b32 s50, s50, 1
    v_or_b32 v26, s50, v26
    v_lshlrev_b32 v27, 2, v12
    v_xor_b32 v26, v26, v27
    v_lshlrev_b32 v27, 1, v15
    v_xor_b32 v26, v26, v27
    v_lshl_add_u32 v26, v26, 4, v14
    v_lshl_add_u32 v26, v15, 14, v26
    v_and_b32 v27, 1, v13
    v_lshl_add_u32 v26, v27, 3, v26
    v_xor_b32 v27, 32, v26
    v_add_u32 v12, 130048, v26
    v_add_u32 v13, 49152, v26
    v_add_u32 v14, 81920, v26
    v_add_u32 v10, 130048, v27
    v_add_u32 v11, 49152, v27
    v_add_u32 v15, 81920, v27
    s_lshl_b32 s50, s8, 10
    s_and_b32 s51, s3, 1
    s_lshl_b32 s51, s51, 9
    s_add_u32 s50, s50, s51
    s_add_u32 s50, s50, 16384
    v_lshlrev_b32 v24, 3, v7
    v_add_u32 v24, s50, v24
    s_waitcnt vmcnt(4)
    s_barrier
    ds_read_b64_tr_b16 v[32:33], v12 offset:0
    ds_read_b64_tr_b16 v[34:35], v12 offset:1024
    ds_read_b64_tr_b16 v[40:41], v8 offset:0
    ds_read_b64_tr_b16 v[42:43], v8 offset:1024
    ds_read_b64_tr_b16 v[44:45], v9 offset:0
    ds_read_b64_tr_b16 v[46:47], v9 offset:1024
    ds_read_b64_tr_b16 v[36:37], v10 offset:0
    ds_read_b64_tr_b16 v[38:39], v10 offset:1024
    s_waitcnt lgkmcnt(4)
    v_mfma_f32_32x32x16_bf16 v[64:79], v[32:35], v[40:43], 0
    ds_read_b64_tr_b16 v[48:49], v12 offset:4096
    ds_read_b64_tr_b16 v[50:51], v12 offset:5120
    ds_read_b64_tr_b16 v[56:57], v8 offset:4096
    ds_read_b64_tr_b16 v[58:59], v8 offset:5120
    s_waitcnt lgkmcnt(6)
    v_mfma_f32_32x32x16_bf16 v[80:95], v[32:35], v[44:47], 0
    ds_read_b64_tr_b16 v[60:61], v9 offset:4096
    ds_read_b64_tr_b16 v[62:63], v9 offset:5120
    s_waitcnt lgkmcnt(6)
    v_mfma_f32_32x32x16_bf16 v[96:111], v[36:39], v[40:43], 0
    ds_read_b64_tr_b16 v[52:53], v10 offset:4096
    ds_read_b64_tr_b16 v[54:55], v10 offset:5120
    v_mfma_f32_32x32x16_bf16 v[112:127], v[36:39], v[44:47], 0
    s_waitcnt lgkmcnt(4)
    v_mfma_f32_32x32x16_bf16 v[64:79], v[48:51], v[56:59], v[64:79]
    ds_read_b64_tr_b16 v[32:33], v12 offset:8192
    ds_read_b64_tr_b16 v[34:35], v12 offset:9216
    ds_read_b64_tr_b16 v[40:41], v8 offset:8192
    ds_read_b64_tr_b16 v[42:43], v8 offset:9216
    s_waitcnt lgkmcnt(6)
    v_mfma_f32_32x32x16_bf16 v[80:95], v[48:51], v[60:63], v[80:95]
    ds_read_b64_tr_b16 v[44:45], v9 offset:8192
    ds_read_b64_tr_b16 v[46:47], v9 offset:9216
    s_waitcnt lgkmcnt(6)
    v_mfma_f32_32x32x16_bf16 v[96:111], v[52:55], v[56:59], v[96:111]
    ds_read_b64_tr_b16 v[36:37], v10 offset:8192
    ds_read_b64_tr_b16 v[38:39], v10 offset:9216
    v_mfma_f32_32x32x16_bf16 v[112:127], v[52:55], v[60:63], v[112:127]
    s_waitcnt lgkmcnt(4)
    v_mfma_f32_32x32x16_bf16 v[64:79], v[32:35], v[40:43], v[64:79]
    ds_read_b64_tr_b16 v[48:49], v12 offset:12288
    ds_read_b64_tr_b16 v[50:51], v12 offset:13312
    ds_read_b64_tr_b16 v[56:57], v8 offset:12288
    ds_read_b64_tr_b16 v[58:59], v8 offset:13312
    s_waitcnt lgkmcnt(6)
    v_mfma_f32_32x32x16_bf16 v[80:95], v[32:35], v[44:47], v[80:95]
    ds_read_b64_tr_b16 v[60:61], v9 offset:12288
    ds_read_b64_tr_b16 v[62:63], v9 offset:13312
    s_waitcnt lgkmcnt(6)
    v_mfma_f32_32x32x16_bf16 v[96:111], v[36:39], v[40:43], v[96:111]
    ds_read_b64_tr_b16 v[52:53], v10 offset:12288
    ds_read_b64_tr_b16 v[54:55], v10 offset:13312
    v_mfma_f32_32x32x16_bf16 v[112:127], v[36:39], v[44:47], v[112:127]
    s_waitcnt vmcnt(2) lgkmcnt(0)
    s_barrier
    s_cmp_ge_u32 s3, 4
    s_cbranch_scc0 G1_nst0
    v_add_u32 v28, 130048, v29
    ds_write_b128 v28, v[200:203] offset:0
    ds_write_b128 v28, v[204:207] offset:16384
    ds_write_b128 v28, v[208:211] offset:1024
    ds_write_b128 v28, v[212:215] offset:17408
    ds_write_b128 v28, v[216:219] offset:2048
    ds_write_b128 v28, v[220:223] offset:18432
    ds_write_b128 v28, v[224:227] offset:3072
    ds_write_b128 v28, v[228:231] offset:19456
    s_waitcnt lgkmcnt(0)
G1_nst0:
    v_mfma_f32_32x32x16_bf16 v[64:79], v[48:51], v[56:59], v[64:79]
    ds_read_b64_tr_b16 v[32:33], v13 offset:0
    ds_read_b64_tr_b16 v[34:35], v13 offset:1024
    ds_read_b64_tr_b16 v[40:41], v8 offset:16384
    ds_read_b64_tr_b16 v[42:43], v8 offset:17408
    s_add_u32 s50, s48, 0
    s_mov_b32 m0, s50
    s_add_u32 s51, s48, 49152
    buffer_load_dwordx4 v3, s[12:15], s51 offen sc1 lds
    v_mfma_f32_32x32x16_bf16 v[80:95], v[48:51], v[60:63], v[80:95]
    ds_read_b64_tr_b16 v[44:45], v9 offset:16384
    ds_read_b64_tr_b16 v[46:47], v9 offset:17408
    s_add_u32 s50, s48, 1024
    s_mov_b32 m0, s50
    s_add_u32 s51, s48, 50176
    buffer_load_dwordx4 v3, s[12:15], s51 offen sc1 lds
    v_mfma_f32_32x32x16_bf16 v[96:111], v[52:55], v[56:59], v[96:111]
    ds_read_b64_tr_b16 v[36:37], v11 offset:0
    ds_read_b64_tr_b16 v[38:39], v11 offset:1024
    v_mfma_f32_32x32x16_bf16 v[112:127], v[52:55], v[60:63], v[112:127]
    s_waitcnt lgkmcnt(4)
    v_mfma_f32_32x32x16_bf16 v[64:79], v[32:35], v[40:43], v[64:79]
    ds_read_b64_tr_b16 v[48:49], v13 offset:4096
    ds_read_b64_tr_b16 v[50:51], v13 offset:5120
    ds_read_b64_tr_b16 v[56:57], v8 offset:20480
    ds_read_b64_tr_b16 v[58:59], v8 offset:21504
    s_waitcnt lgkmcnt(6)
    v_mfma_f32_32x32x16_bf16 v[80:95], v[32:35], v[44:47], v[80:95]
    ds_read_b64_tr_b16 v[60:61], v9 offset:20480
    ds_read_b64_tr_b16 v[62:63], v9 offset:21504
    s_waitcnt lgkmcnt(6)
    v_mfma_f32_32x32x16_bf16 v[96:111], v[36:39], v[40:43], v[96:111]
    ds_read_b64_tr_b16 v[52:53], v11 offset:4096
    ds_read_b64_tr_b16 v[54:55], v11 offset:5120
    v_mfma_f32_32x32x16_bf16 v[112:127], v[36:39], v[44:47], v[112:127]
    s_waitcnt lgkmcnt(4)
    v_mfma_f32_32x32x16_bf16 v[64:79], v[48:51], v[56:59], v[64:79]
    ds_read_b64_tr_b16 v[32:33], v13 offset:8192
    ds_read_b64_tr_b16 v[34:35], v13 offset:9216
    ds_read_b64_tr_b16 v[40:41], v8 offset:24576
    ds_read_b64_tr_b16 v[42:43], v8 offset:25600
    s_waitcnt lgkmcnt(6)
    v_mfma_f32_32x32x16_bf16 v[80:95], v[48:51], v[60:63], v[80:95]
    ds_read_b64_tr_b16 v[44:45], v9 offset:24576
    ds_read_b64_tr_b16 v[46:47], v9 offset:25600
    s_waitcnt lgkmcnt(6)
    v_mfma_f32_32x32x16_bf16 v[96:111], v[52:55], v[56:59], v[96:111]
    ds_read_b64_tr_b16 v[36:37], v11 offset:8192
    ds_read_b64_tr_b16 v[38:39], v11 offset:9216
    v_mfma_f32_32x32x16_bf16 v[112:127], v[52:55], v[60:63], v[112:127]
    s_waitcnt lgkmcnt(4)
    v_mfma_f32_32x32x16_bf16 v[64:79], v[32:35], v[40:43], v[64:79]
    ds_read_b64_tr_b16 v[48:49], v13 offset:12288
    ds_read_b64_tr_b16 v[50:51], v13 offset:13312
    ds_read_b64_tr_b16 v[56:57], v8 offset:28672
    ds_read_b64_tr_b16 v[58:59], v8 offset:29696
    s_waitcnt lgkmcnt(6)
    v_mfma_f32_32x32x16_bf16 v[80:95], v[32:35], v[44:47], v[80:95]
    ds_read_b64_tr_b16 v[60:61], v9 offset:28672
    ds_read_b64_tr_b16 v[62:63], v9 offset:29696
    s_waitcnt lgkmcnt(6)
    v_mfma_f32_32x32x16_bf16 v[96:111], v[36:39], v[40:43], v[96:111]
    ds_read_b64_tr_b16 v[52:53], v11 offset:12288
    ds_read_b64_tr_b16 v[54:55], v11 offset:13312
    v_mfma_f32_32x32x16_bf16 v[112:127], v[36:39], v[44:47], v[112:127]
    s_waitcnt vmcnt(2) lgkmcnt(0)
    s_barrier
    s_cmp_ge_u32 s3, 4
    s_cbranch_scc0 G1_nst1
    v_add_u32 v28, 49152, v29
    ds_write_b128 v28, v[232:235] offset:0
    ds_write_b128 v28, v[236:239] offset:16384
    ds_write_b128 v28, v[240:243] offset:1024
    ds_write_b128 v28, v[244:247] offset:17408
    ds_write_b128 v28, v[248:251] offset:2048
    ds_write_b128 v28, v[252:255] offset:18432
    ds_write_b128 v28, v[128:131] offset:3072
    ds_write_b128 v28, v[132:135] offset:19456
    s_waitcnt lgkmcnt(0)
G1_nst1:
    v_mfma_f32_32x32x16_bf16 v[64:79], v[48:51], v[56:59], v[64:79]
    ds_read_b64_tr_b16 v[32:33], v14 offset:0
    ds_read_b64_tr_b16 v[34:35], v14 offset:1024
    ds_read_b64_tr_b16 v[40:41], v8 offset:32768
    ds_read_b64_tr_b16 v[42:43], v8 offset:33792
    s_add_u32 s50, s48, 16384
    s_mov_b32 m0, s50
    s_add_u32 s51, s48, 65536
    buffer_load_dwordx4 v3, s[12:15], s51 offen sc1 lds
    v_mfma_f32_32x32x16_bf16 v[80:95], v[48:51], v[60:63], v[80:95]
    ds_read_b64_tr_b16 v[44:45], v9 offset:32768
    ds_read_b64_tr_b16 v[46:47], v9 offset:33792
    s_add_u32 s50, s48, 17408
    s_mov_b32 m0, s50
    s_add_u32 s51, s48, 66560
    buffer_load_dwordx4 v3, s[12:15], s51 offen sc1 lds
    v_mfma_f32_32x32x16_bf16 v[96:111], v[52:55], v[56:59], v[96:111]
    ds_read_b64_tr_b16 v[36:37], v15 offset:0
    ds_read_b64_tr_b16 v[38:39], v15 offset:1024
    v_mfma_f32_32x32x16_bf16 v[112:127], v[52:55], v[60:63], v[112:127]
    s_waitcnt lgkmcnt(4)
    v_mfma_f32_32x32x16_bf16 v[64:79], v[32:35], v[40:43], v[64:79]
    ds_read_b64_tr_b16 v[48:49], v14 offset:4096
    ds_read_b64_tr_b16 v[50:51], v14 offset:5120
    ds_read_b64_tr_b16 v[56:57], v8 offset:36864
    ds_read_b64_tr_b16 v[58:59], v8 offset:37888
    s_waitcnt lgkmcnt(6)
    v_mfma_f32_32x32x16_bf16 v[80:95], v[32:35], v[44:47], v[80:95]
    ds_read_b64_tr_b16 v[60:61], v9 offset:36864
    ds_read_b64_tr_b16 v[62:63], v9 offset:37888
    s_waitcnt lgkmcnt(6)
    v_mfma_f32_32x32x16_bf16 v[96:111], v[36:39], v[40:43], v[96:111]
    ds_read_b64_tr_b16 v[52:53], v15 offset:4096
    ds_read_b64_tr_b16 v[54:55], v15 offset:5120
    v_mfma_f32_32x32x16_bf16 v[112:127], v[36:39], v[44:47], v[112:127]
    s_waitcnt lgkmcnt(4)
    v_mfma_f32_32x32x16_bf16 v[64:79], v[48:51], v[56:59], v[64:79]
    ds_read_b64_tr_b16 v[32:33], v14 offset:8192
    ds_read_b64_tr_b16 v[34:35], v14 offset:9216
    ds_read_b64_tr_b16 v[40:41], v8 offset:40960
    ds_read_b64_tr_b16 v[42:43], v8 offset:41984
    s_waitcnt lgkmcnt(6)
    v_mfma_f32_32x32x16_bf16 v[80:95], v[48:51], v[60:63], v[80:95]
    ds_read_b64_tr_b16 v[44:45], v9 offset:40960
    ds_read_b64_tr_b16 v[46:47], v9 offset:41984
    s_waitcnt lgkmcnt(6)
    v_mfma_f32_32x32x16_bf16 v[96:111], v[52:55], v[56:59], v[96:111]
    ds_read_b64_tr_b16 v[36:37], v15 offset:8192
    ds_read_b64_tr_b16 v[38:39], v15 offset:9216
    v_mfma_f32_32x32x16_bf16 v[112:127], v[52:55], v[60:63], v[112:127]
    s_waitcnt lgkmcnt(4)
    v_mfma_f32_32x32x16_bf16 v[64:79], v[32:35], v[40:43], v[64:79]
    ds_read_b64_tr_b16 v[48:49], v14 offset:12288
    ds_read_b64_tr_b16 v[50:51], v14 offset:13312
    ds_read_b64_tr_b16 v[56:57], v8 offset:45056
    ds_read_b64_tr_b16 v[58:59], v8 offset:46080
    global_load_dwordx4 v[144:147], v30, s[46:47] offset:0 sc1
    s_waitcnt lgkmcnt(6)
    v_mfma_f32_32x32x16_bf16 v[80:95], v[32:35], v[44:47], v[80:95]
    ds_read_b64_tr_b16 v[60:61], v9 offset:45056
    ds_read_b64_tr_b16 v[62:63], v9 offset:46080
    global_load_dwordx4 v[148:151], v31, s[46:47] offset:0 sc1
    s_waitcnt lgkmcnt(6)
    v_mfma_f32_32x32x16_bf16 v[96:111], v[36:39], v[40:43], v[96:111]
    ds_read_b64_tr_b16 v[52:53], v15 offset:12288
    ds_read_b64_tr_b16 v[54:55], v15 offset:13312
    v_mfma_f32_32x32x16_bf16 v[112:127], v[36:39], v[44:47], v[112:127]
    s_waitcnt vmcnt(4) lgkmcnt(0)
    s_barrier
    v_mfma_f32_32x32x16_bf16 v[64:79], v[48:51], v[56:59], v[64:79]
    ds_read_b64_tr_b16 v[32:33], v12 offset:0
    ds_read_b64_tr_b16 v[34:35], v12 offset:1024
    ds_read_b64_tr_b16 v[40:41], v8 offset:0
    ds_read_b64_tr_b16 v[42:43], v8 offset:1024
    s_add_u32 s50, s48, 32768
    s_mov_b32 m0, s50
    s_add_u32 s51, s48, 81920
    buffer_load_dwordx4 v3, s[12:15], s51 offen sc1 lds
    v_mfma_f32_32x32x16_bf16 v[80:95], v[48:51], v[60:63], v[80:95]
    ds_read_b64_tr_b16 v[44:45], v9 offset:0
    ds_read_b64_tr_b16 v[46:47], v9 offset:1024
    s_add_u32 s50, s48, 33792
    s_mov_b32 m0, s50
    s_add_u32 s51, s48, 82944
    buffer_load_dwordx4 v3, s[12:15], s51 offen sc1 lds
    v_mfma_f32_32x32x16_bf16 v[96:111], v[52:55], v[56:59], v[96:111]
    ds_read_b64_tr_b16 v[36:37], v10 offset:0
    ds_read_b64_tr_b16 v[38:39], v10 offset:1024
    s_add_u32 s50, s48, 81920
    s_mov_b32 m0, s50
    s_add_u32 s51, s49, 1146880
    buffer_load_dwordx4 v5, s[52:55], s51 offen lds
    v_mfma_f32_32x32x16_bf16 v[112:127], v[52:55], v[60:63], v[112:127]
    s_add_u32 s50, s48, 98304
    s_mov_b32 m0, s50
    s_add_u32 s51, s49, 1146880
    buffer_load_dwordx4 v6, s[56:59], s51 offen lds
    s_waitcnt lgkmcnt(4)
    v_mfma_f32_32x32x16_bf16 v[64:79], v[32:35], v[40:43], v[64:79]
    ds_read_b64_tr_b16 v[48:49], v12 offset:4096
    ds_read_b64_tr_b16 v[50:51], v12 offset:5120
    ds_read_b64_tr_b16 v[56:57], v8 offset:4096
    ds_read_b64_tr_b16 v[58:59], v8 offset:5120
    s_add_u32 s50, s48, 82944
    s_mov_b32 m0, s50
    s_add_u32 s51, s49, 1161216
    buffer_load_dwordx4 v5, s[52:55], s51 offen lds
    s_waitcnt lgkmcnt(6)
    v_mfma_f32_32x32x16_bf16 v[80:95], v[32:35], v[44:47], v[80:95]
    ds_read_b64_tr_b16 v[60:61], v9 offset:4096
    ds_read_b64_tr_b16 v[62:63], v9 offset:5120
    s_add_u32 s50, s48, 99328
    s_mov_b32 m0, s50
    s_add_u32 s51, s49, 1161216
    buffer_load_dwordx4 v6, s[56:59], s51 offen lds
    s_waitcnt lgkmcnt(6)
    v_mfma_f32_32x32x16_bf16 v[96:111], v[36:39], v[40:43], v[96:111]
    ds_read_b64_tr_b16 v[52:53], v10 offset:4096
    ds_read_b64_tr_b16 v[54:55], v10 offset:5120
    v_mfma_f32_32x32x16_bf16 v[112:127], v[36:39], v[44:47], v[112:127]
    s_waitcnt lgkmcnt(4)
    v_mfma_f32_32x32x16_bf16 v[64:79], v[48:51], v[56:59], v[64:79]
    ds_read_b64_tr_b16 v[32:33], v12 offset:8192
    ds_read_b64_tr_b16 v[34:35], v12 offset:9216
    ds_read_b64_tr_b16 v[40:41], v8 offset:8192
    ds_read_b64_tr_b16 v[42:43], v8 offset:9216
    global_load_dwordx4 v[152:155], v30, s[46:47] offset:1024 sc1
    s_waitcnt lgkmcnt(6)
    v_mfma_f32_32x32x16_bf16 v[80:95], v[48:51], v[60:63], v[80:95]
    ds_read_b64_tr_b16 v[44:45], v9 offset:8192
    ds_read_b64_tr_b16 v[46:47], v9 offset:9216
    global_load_dwordx4 v[156:159], v31, s[46:47] offset:1024 sc1
    s_waitcnt lgkmcnt(6)
    v_mfma_f32_32x32x16_bf16 v[96:111], v[52:55], v[56:59], v[96:111]
    ds_read_b64_tr_b16 v[36:37], v10 offset:8192
    ds_read_b64_tr_b16 v[38:39], v10 offset:9216
    v_mfma_f32_32x32x16_bf16 v[112:127], v[52:55], v[60:63], v[112:127]
    s_waitcnt lgkmcnt(4)
    v_mfma_f32_32x32x16_bf16 v[64:79], v[32:35], v[40:43], v[64:79]
    ds_read_b64_tr_b16 v[48:49], v12 offset:12288
    ds_read_b64_tr_b16 v[50:51], v12 offset:13312
    ds_read_b64_tr_b16 v[56:57], v8 offset:12288
    ds_read_b64_tr_b16 v[58:59], v8 offset:13312
    global_load_dwordx4 v[160:163], v30, s[46:47] offset:2048 sc1
    s_waitcnt lgkmcnt(6)
    v_mfma_f32_32x32x16_bf16 v[80:95], v[32:35], v[44:47], v[80:95]
    ds_read_b64_tr_b16 v[60:61], v9 offset:12288
    ds_read_b64_tr_b16 v[62:63], v9 offset:13312
    global_load_dwordx4 v[164:167], v31, s[46:47] offset:2048 sc1
    s_waitcnt lgkmcnt(6)
    v_mfma_f32_32x32x16_bf16 v[96:111], v[36:39], v[40:43], v[96:111]
    ds_read_b64_tr_b16 v[52:53], v10 offset:12288
    ds_read_b64_tr_b16 v[54:55], v10 offset:13312
    v_mfma_f32_32x32x16_bf16 v[112:127], v[36:39], v[44:47], v[112:127]
    s_waitcnt vmcnt(12) lgkmcnt(0)
    s_barrier
    v_mfma_f32_32x32x16_bf16 v[64:79], v[48:51], v[56:59], v[64:79]
    ds_read_b64_tr_b16 v[32:33], v13 offset:0
    ds_read_b64_tr_b16 v[34:35], v13 offset:1024
    ds_read_b64_tr_b16 v[40:41], v8 offset:16384
    ds_read_b64_tr_b16 v[42:43], v8 offset:17408
    s_add_u32 s50, s48, 0
    s_mov_b32 m0, s50
    s_add_u32 s51, s48, 98304
    buffer_load_dwordx4 v3, s[12:15], s51 offen sc1 lds
    v_mfma_f32_32x32x16_bf16 v[80:95], v[48:51], v[60:63], v[80:95]
    ds_read_b64_tr_b16 v[44:45], v9 offset:16384
    ds_read_b64_tr_b16 v[46:47], v9 offset:17408
    s_add_u32 s50, s48, 1024
    s_mov_b32 m0, s50
    s_add_u32 s51, s48, 99328
    buffer_load_dwordx4 v3, s[12:15], s51 offen sc1 lds
    v_mfma_f32_32x32x16_bf16 v[96:111], v[52:55], v[56:59], v[96:111]
    ds_read_b64_tr_b16 v[36:37], v11 offset:0
    ds_read_b64_tr_b16 v[38:39], v11 offset:1024
    s_add_u32 s50, s48, 130048
    s_mov_b32 m0, s50
    s_add_u32 s51, s49, 1376256
    buffer_load_dwordx4 v5, s[52:55], s51 offen lds
    v_mfma_f32_32x32x16_bf16 v[112:127], v[52:55], v[60:63], v[112:127]
    s_add_u32 s50, s48, 146432
    s_mov_b32 m0, s50
    s_add_u32 s51, s49, 1376256
    buffer_load_dwordx4 v6, s[56:59], s51 offen lds
    s_waitcnt lgkmcnt(4)
    v_mfma_f32_32x32x16_bf16 v[64:79], v[32:35], v[40:43], v[64:79]
    ds_read_b64_tr_b16 v[48:49], v13 offset:4096
    ds_read_b64_tr_b16 v[50:51], v13 offset:5120
    ds_read_b64_tr_b16 v[56:57], v8 offset:20480
    ds_read_b64_tr_b16 v[58:59], v8 offset:21504
    s_add_u32 s50, s48, 131072
    s_mov_b32 m0, s50
    s_add_u32 s51, s49, 1390592
    buffer_load_dwordx4 v5, s[52:55], s51 offen lds
    s_waitcnt lgkmcnt(6)
    v_mfma_f32_32x32x16_bf16 v[80:95], v[32:35], v[44:47], v[80:95]
    ds_read_b64_tr_b16 v[60:61], v9 offset:20480
    ds_read_b64_tr_b16 v[62:63], v9 offset:21504
    s_add_u32 s50, s48, 147456
    s_mov_b32 m0, s50
    s_add_u32 s51, s49, 1390592
    buffer_load_dwordx4 v6, s[56:59], s51 offen lds
    s_waitcnt lgkmcnt(6)
    v_mfma_f32_32x32x16_bf16 v[96:111], v[36:39], v[40:43], v[96:111]
    ds_read_b64_tr_b16 v[52:53], v11 offset:4096
    ds_read_b64_tr_b16 v[54:55], v11 offset:5120
    v_mfma_f32_32x32x16_bf16 v[112:127], v[36:39], v[44:47], v[112:127]
    s_waitcnt lgkmcnt(4)
    v_mfma_f32_32x32x16_bf16 v[64:79], v[48:51], v[56:59], v[64:79]
    ds_read_b64_tr_b16 v[32:33], v13 offset:8192
    ds_read_b64_tr_b16 v[34:35], v13 offset:9216
    ds_read_b64_tr_b16 v[40:41], v8 offset:24576
    ds_read_b64_tr_b16 v[42:43], v8 offset:25600
    global_load_dwordx4 v[168:171], v30, s[46:47] offset:3072 sc1
    v_add_u32 v30, 4096, v30
    s_waitcnt lgkmcnt(6)
    v_mfma_f32_32x32x16_bf16 v[80:95], v[48:51], v[60:63], v[80:95]
    ds_read_b64_tr_b16 v[44:45], v9 offset:24576
    ds_read_b64_tr_b16 v[46:47], v9 offset:25600
    global_load_dwordx4 v[172:175], v31, s[46:47] offset:3072 sc1
    v_add_u32 v31, 4096, v31
    s_waitcnt lgkmcnt(6)
    v_mfma_f32_32x32x16_bf16 v[96:111], v[52:55], v[56:59], v[96:111]
    ds_read_b64_tr_b16 v[36:37], v11 offset:8192
    ds_read_b64_tr_b16 v[38:39], v11 offset:9216
    v_mfma_f32_32x32x16_bf16 v[112:127], v[52:55], v[60:63], v[112:127]
    s_waitcnt lgkmcnt(4)
    v_mfma_f32_32x32x16_bf16 v[64:79], v[32:35], v[40:43], v[64:79]
    ds_read_b64_tr_b16 v[48:49], v13 offset:12288
    ds_read_b64_tr_b16 v[50:51], v13 offset:13312
    ds_read_b64_tr_b16 v[56:57], v8 offset:28672
    ds_read_b64_tr_b16 v[58:59], v8 offset:29696
    global_load_dwordx4 v[176:179], v30, s[46:47] offset:0 sc1
    s_waitcnt lgkmcnt(6)
    v_mfma_f32_32x32x16_bf16 v[80:95], v[32:35], v[44:47], v[80:95]
    ds_read_b64_tr_b16 v[60:61], v9 offset:28672
    ds_read_b64_tr_b16 v[62:63], v9 offset:29696
    global_load_dwordx4 v[180:183], v31, s[46:47] offset:0 sc1
    s_waitcnt lgkmcnt(6)
    v_mfma_f32_32x32x16_bf16 v[96:111], v[36:39], v[40:43], v[96:111]
    ds_read_b64_tr_b16 v[52:53], v11 offset:12288
    ds_read_b64_tr_b16 v[54:55], v11 offset:13312
    v_mfma_f32_32x32x16_bf16 v[112:127], v[36:39], v[44:47], v[112:127]
    s_waitcnt vmcnt(14) lgkmcnt(0)
    s_barrier
    v_mfma_f32_32x32x16_bf16 v[64:79], v[48:51], v[56:59], v[64:79]
    ds_read_b64_tr_b16 v[32:33], v14 offset:0
    ds_read_b64_tr_b16 v[34:35], v14 offset:1024
    ds_read_b64_tr_b16 v[40:41], v8 offset:32768
    ds_read_b64_tr_b16 v[42:43], v8 offset:33792
    s_add_u32 s50, s48, 16384
    s_mov_b32 m0, s50
    s_add_u32 s51, s48, 114688
    buffer_load_dwordx4 v3, s[12:15], s51 offen sc1 lds
    v_mfma_f32_32x32x16_bf16 v[80:95], v[48:51], v[60:63], v[80:95]
    ds_read_b64_tr_b16 v[44:45], v9 offset:32768
    ds_read_b64_tr_b16 v[46:47], v9 offset:33792
    s_add_u32 s50, s48, 17408
    s_mov_b32 m0, s50
    s_add_u32 s51, s48, 115712
    buffer_load_dwordx4 v3, s[12:15], s51 offen sc1 lds
    v_mfma_f32_32x32x16_bf16 v[96:111], v[52:55], v[56:59], v[96:111]
    ds_read_b64_tr_b16 v[36:37], v15 offset:0
    ds_read_b64_tr_b16 v[38:39], v15 offset:1024
    s_add_u32 s50, s48, 49152
    s_mov_b32 m0, s50
    s_add_u32 s51, s49, 1605632
    buffer_load_dwordx4 v5, s[52:55], s51 offen lds
    v_mfma_f32_32x32x16_bf16 v[112:127], v[52:55], v[60:63], v[112:127]
    s_add_u32 s50, s48, 65536
    s_mov_b32 m0, s50
    s_add_u32 s51, s49, 1605632
    buffer_load_dwordx4 v6, s[56:59], s51 offen lds
    s_waitcnt lgkmcnt(4)
    v_mfma_f32_32x32x16_bf16 v[64:79], v[32:35], v[40:43], v[64:79]
    ds_read_b64_tr_b16 v[48:49], v14 offset:4096
    ds_read_b64_tr_b16 v[50:51], v14 offset:5120
    ds_read_b64_tr_b16 v[56:57], v8 offset:36864
    ds_read_b64_tr_b16 v[58:59], v8 offset:37888
    s_add_u32 s50, s48, 50176
    s_mov_b32 m0, s50
    s_add_u32 s51, s49, 1619968
    buffer_load_dwordx4 v5, s[52:55], s51 offen lds
    s_waitcnt lgkmcnt(6)
    v_mfma_f32_32x32x16_bf16 v[80:95], v[32:35], v[44:47], v[80:95]
    ds_read_b64_tr_b16 v[60:61], v9 offset:36864
    ds_read_b64_tr_b16 v[62:63], v9 offset:37888
    s_add_u32 s50, s48, 66560
    s_mov_b32 m0, s50
    s_add_u32 s51, s49, 1619968
    buffer_load_dwordx4 v6, s[56:59], s51 offen lds
    s_waitcnt lgkmcnt(6)
    v_mfma_f32_32x32x16_bf16 v[96:111], v[36:39], v[40:43], v[96:111]
    ds_read_b64_tr_b16 v[52:53], v15 offset:4096
    ds_read_b64_tr_b16 v[54:55], v15 offset:5120
    v_mfma_f32_32x32x16_bf16 v[112:127], v[36:39], v[44:47], v[112:127]
    s_waitcnt lgkmcnt(4)
    v_mfma_f32_32x32x16_bf16 v[64:79], v[48:51], v[56:59], v[64:79]
    ds_read_b64_tr_b16 v[32:33], v14 offset:8192
    ds_read_b64_tr_b16 v[34:35], v14 offset:9216
    ds_read_b64_tr_b16 v[40:41], v8 offset:40960
    ds_read_b64_tr_b16 v[42:43], v8 offset:41984
    global_load_dwordx4 v[184:187], v30, s[46:47] offset:1024 sc1
    s_waitcnt lgkmcnt(6)
    v_mfma_f32_32x32x16_bf16 v[80:95], v[48:51], v[60:63], v[80:95]
    ds_read_b64_tr_b16 v[44:45], v9 offset:40960
    ds_read_b64_tr_b16 v[46:47], v9 offset:41984
    global_load_dwordx4 v[188:191], v31, s[46:47] offset:1024 sc1
    s_waitcnt lgkmcnt(6)
    v_mfma_f32_32x32x16_bf16 v[96:111], v[52:55], v[56:59], v[96:111]
    ds_read_b64_tr_b16 v[36:37], v15 offset:8192
    ds_read_b64_tr_b16 v[38:39], v15 offset:9216
    v_mfma_f32_32x32x16_bf16 v[112:127], v[52:55], v[60:63], v[112:127]
    s_waitcnt lgkmcnt(4)
    v_mfma_f32_32x32x16_bf16 v[64:79], v[32:35], v[40:43], v[64:79]
    ds_read_b64_tr_b16 v[48:49], v14 offset:12288
    ds_read_b64_tr_b16 v[50:51], v14 offset:13312
    ds_read_b64_tr_b16 v[56:57], v8 offset:45056
    ds_read_b64_tr_b16 v[58:59], v8 offset:46080
    global_load_dwordx4 v[192:195], v30, s[46:47] offset:2048 sc1
    s_waitcnt lgkmcnt(6)
    v_mfma_f32_32x32x16_bf16 v[80:95], v[32:35], v[44:47], v[80:95]
    ds_read_b64_tr_b16 v[60:61], v9 offset:45056
    ds_read_b64_tr_b16 v[62:63], v9 offset:46080
    global_load_dwordx4 v[196:199], v31, s[46:47] offset:2048 sc1
    s_waitcnt lgkmcnt(6)
    v_mfma_f32_32x32x16_bf16 v[96:111], v[36:39], v[40:43], v[96:111]
    ds_read_b64_tr_b16 v[52:53], v15 offset:12288
    ds_read_b64_tr_b16 v[54:55], v15 offset:13312
    v_mfma_f32_32x32x16_bf16 v[112:127], v[36:39], v[44:47], v[112:127]
    s_waitcnt vmcnt(14) lgkmcnt(0)
    s_barrier
    v_mfma_f32_32x32x16_bf16 v[64:79], v[48:51], v[56:59], v[64:79]
    ds_read_b64_tr_b16 v[32:33], v12 offset:0
    ds_read_b64_tr_b16 v[34:35], v12 offset:1024
    ds_read_b64_tr_b16 v[40:41], v8 offset:0
    ds_read_b64_tr_b16 v[42:43], v8 offset:1024
    global_load_dwordx4 v[200:203], v30, s[46:47] offset:3072 sc1
    v_add_u32 v30, 4096, v30
    v_mfma_f32_32x32x16_bf16 v[80:95], v[48:51], v[60:63], v[80:95]
    ds_read_b64_tr_b16 v[44:45], v9 offset:0
    ds_read_b64_tr_b16 v[46:47], v9 offset:1024
    global_load_dwordx4 v[204:207], v31, s[46:47] offset:3072 sc1
    v_add_u32 v31, 4096, v31
    v_mfma_f32_32x32x16_bf16 v[96:111], v[52:55], v[56:59], v[96:111]
    ds_read_b64_tr_b16 v[36:37], v10 offset:0
    ds_read_b64_tr_b16 v[38:39], v10 offset:1024
    v_mfma_f32_32x32x16_bf16 v[112:127], v[52:55], v[60:63], v[112:127]
    s_waitcnt lgkmcnt(4)
    v_mfma_f32_32x32x16_bf16 v[64:79], v[32:35], v[40:43], v[64:79]
    ds_read_b64_tr_b16 v[48:49], v12 offset:4096
    ds_read_b64_tr_b16 v[50:51], v12 offset:5120
    ds_read_b64_tr_b16 v[56:57], v8 offset:4096
    ds_read_b64_tr_b16 v[58:59], v8 offset:5120
    global_load_dwordx4 v[208:211], v30, s[46:47] offset:0 sc1
    s_waitcnt lgkmcnt(6)
    v_mfma_f32_32x32x16_bf16 v[80:95], v[32:35], v[44:47], v[80:95]
    ds_read_b64_tr_b16 v[60:61], v9 offset:4096
    ds_read_b64_tr_b16 v[62:63], v9 offset:5120
    global_load_dwordx4 v[212:215], v31, s[46:47] offset:0 sc1
    s_waitcnt lgkmcnt(6)
    v_mfma_f32_32x32x16_bf16 v[96:111], v[36:39], v[40:43], v[96:111]
    ds_read_b64_tr_b16 v[52:53], v10 offset:4096
    ds_read_b64_tr_b16 v[54:55], v10 offset:5120
    v_mfma_f32_32x32x16_bf16 v[112:127], v[36:39], v[44:47], v[112:127]
    s_waitcnt lgkmcnt(4)
    v_mfma_f32_32x32x16_bf16 v[64:79], v[48:51], v[56:59], v[64:79]
    ds_read_b64_tr_b16 v[32:33], v12 offset:8192
    ds_read_b64_tr_b16 v[34:35], v12 offset:9216
    ds_read_b64_tr_b16 v[40:41], v8 offset:8192
    ds_read_b64_tr_b16 v[42:43], v8 offset:9216
    global_load_dwordx4 v[216:219], v30, s[46:47] offset:1024 sc1
    s_waitcnt lgkmcnt(6)
    v_mfma_f32_32x32x16_bf16 v[80:95], v[48:51], v[60:63], v[80:95]
    ds_read_b64_tr_b16 v[44:45], v9 offset:8192
    ds_read_b64_tr_b16 v[46:47], v9 offset:9216
    global_load_dwordx4 v[220:223], v31, s[46:47] offset:1024 sc1
    s_waitcnt lgkmcnt(6)
    v_mfma_f32_32x32x16_bf16 v[96:111], v[52:55], v[56:59], v[96:111]
    ds_read_b64_tr_b16 v[36:37], v10 offset:8192
    ds_read_b64_tr_b16 v[38:39], v10 offset:9216
    v_mfma_f32_32x32x16_bf16 v[112:127], v[52:55], v[60:63], v[112:127]
    s_waitcnt lgkmcnt(4)
    v_mfma_f32_32x32x16_bf16 v[64:79], v[32:35], v[40:43], v[64:79]
    ds_read_b64_tr_b16 v[48:49], v12 offset:12288
    ds_read_b64_tr_b16 v[50:51], v12 offset:13312
    ds_read_b64_tr_b16 v[56:57], v8 offset:12288
    ds_read_b64_tr_b16 v[58:59], v8 offset:13312
    global_load_dwordx4 v[224:227], v30, s[46:47] offset:2048 sc1
    s_waitcnt lgkmcnt(6)
    v_mfma_f32_32x32x16_bf16 v[80:95], v[32:35], v[44:47], v[80:95]
    ds_read_b64_tr_b16 v[60:61], v9 offset:12288
    ds_read_b64_tr_b16 v[62:63], v9 offset:13312
    global_load_dwordx4 v[228:231], v31, s[46:47] offset:2048 sc1
    s_waitcnt lgkmcnt(6)
    v_mfma_f32_32x32x16_bf16 v[96:111], v[36:39], v[40:43], v[96:111]
    ds_read_b64_tr_b16 v[52:53], v10 offset:12288
    ds_read_b64_tr_b16 v[54:55], v10 offset:13312
    v_mfma_f32_32x32x16_bf16 v[112:127], v[36:39], v[44:47], v[112:127]
    s_waitcnt vmcnt(12) lgkmcnt(0)
    s_barrier
    v_mfma_f32_32x32x16_bf16 v[64:79], v[48:51], v[56:59], v[64:79]
    ds_read_b64_tr_b16 v[32:33], v13 offset:0
    ds_read_b64_tr_b16 v[34:35], v13 offset:1024
    ds_read_b64_tr_b16 v[40:41], v8 offset:16384
    ds_read_b64_tr_b16 v[42:43], v8 offset:17408
    global_load_dwordx4 v[232:235], v30, s[46:47] offset:3072 sc1
    v_add_u32 v30, 4096, v30
    v_mfma_f32_32x32x16_bf16 v[80:95], v[48:51], v[60:63], v[80:95]
    ds_read_b64_tr_b16 v[44:45], v9 offset:16384
    ds_read_b64_tr_b16 v[46:47], v9 offset:17408
    global_load_dwordx4 v[236:239], v31, s[46:47] offset:3072 sc1
    v_add_u32 v31, 4096, v31
    v_mfma_f32_32x32x16_bf16 v[96:111], v[52:55], v[56:59], v[96:111]
    ds_read_b64_tr_b16 v[36:37], v11 offset:0
    ds_read_b64_tr_b16 v[38:39], v11 offset:1024
    v_mfma_f32_32x32x16_bf16 v[112:127], v[52:55], v[60:63], v[112:127]
    s_waitcnt lgkmcnt(4)
    v_mfma_f32_32x32x16_bf16 v[64:79], v[32:35], v[40:43], v[64:79]
    ds_read_b64_tr_b16 v[48:49], v13 offset:4096
    ds_read_b64_tr_b16 v[50:51], v13 offset:5120
    ds_read_b64_tr_b16 v[56:57], v8 offset:20480
    ds_read_b64_tr_b16 v[58:59], v8 offset:21504
    global_load_dwordx4 v[240:243], v30, s[46:47] offset:0 sc1
    s_waitcnt lgkmcnt(6)
    v_mfma_f32_32x32x16_bf16 v[80:95], v[32:35], v[44:47], v[80:95]
    ds_read_b64_tr_b16 v[60:61], v9 offset:20480
    ds_read_b64_tr_b16 v[62:63], v9 offset:21504
    global_load_dwordx4 v[244:247], v31, s[46:47] offset:0 sc1
    s_waitcnt lgkmcnt(6)
    v_mfma_f32_32x32x16_bf16 v[96:111], v[36:39], v[40:43], v[96:111]
    ds_read_b64_tr_b16 v[52:53], v11 offset:4096
    ds_read_b64_tr_b16 v[54:55], v11 offset:5120
    v_mfma_f32_32x32x16_bf16 v[112:127], v[36:39], v[44:47], v[112:127]
    s_waitcnt lgkmcnt(4)
    v_mfma_f32_32x32x16_bf16 v[64:79], v[48:51], v[56:59], v[64:79]
    ds_read_b64_tr_b16 v[32:33], v13 offset:8192
    ds_read_b64_tr_b16 v[34:35], v13 offset:9216
    ds_read_b64_tr_b16 v[40:41], v8 offset:24576
    ds_read_b64_tr_b16 v[42:43], v8 offset:25600
    global_load_dwordx4 v[248:251], v30, s[46:47] offset:1024 sc1
    s_waitcnt lgkmcnt(6)
    v_mfma_f32_32x32x16_bf16 v[80:95], v[48:51], v[60:63], v[80:95]
    ds_read_b64_tr_b16 v[44:45], v9 offset:24576
    ds_read_b64_tr_b16 v[46:47], v9 offset:25600
    global_load_dwordx4 v[252:255], v31, s[46:47] offset:1024 sc1
    s_waitcnt lgkmcnt(6)
    v_mfma_f32_32x32x16_bf16 v[96:111], v[52:55], v[56:59], v[96:111]
    ds_read_b64_tr_b16 v[36:37], v11 offset:8192
    ds_read_b64_tr_b16 v[38:39], v11 offset:9216
    global_load_dwordx2 v[20:21], v24, s[46:47] offset:0 sc1
    v_mfma_f32_32x32x16_bf16 v[112:127], v[52:55], v[60:63], v[112:127]
    global_load_dwordx2 v[22:23], v24, s[46:47] offset:256 sc1
    s_waitcnt lgkmcnt(4)
    v_mfma_f32_32x32x16_bf16 v[64:79], v[32:35], v[40:43], v[64:79]
    ds_read_b64_tr_b16 v[48:49], v13 offset:12288
    ds_read_b64_tr_b16 v[50:51], v13 offset:13312
    ds_read_b64_tr_b16 v[56:57], v8 offset:28672
    ds_read_b64_tr_b16 v[58:59], v8 offset:29696
    global_load_dwordx2 v[16:17], v25, s[46:47] offset:0 sc1
    s_waitcnt lgkmcnt(6)
    v_mfma_f32_32x32x16_bf16 v[80:95], v[32:35], v[44:47], v[80:95]
    ds_read_b64_tr_b16 v[60:61], v9 offset:28672
    ds_read_b64_tr_b16 v[62:63], v9 offset:29696
    global_load_dwordx2 v[18:19], v25, s[46:47] offset:256 sc1
    s_waitcnt lgkmcnt(6)
    v_mfma_f32_32x32x16_bf16 v[96:111], v[36:39], v[40:43], v[96:111]
    ds_read_b64_tr_b16 v[52:53], v11 offset:12288
    ds_read_b64_tr_b16 v[54:55], v11 offset:13312
    v_mfma_f32_32x32x16_bf16 v[112:127], v[36:39], v[44:47], v[112:127]
    s_waitcnt lgkmcnt(4)
    v_mfma_f32_32x32x16_bf16 v[64:79], v[48:51], v[56:59], v[64:79]
    s_waitcnt lgkmcnt(2)
    v_mfma_f32_32x32x16_bf16 v[80:95], v[48:51], v[60:63], v[80:95]
    s_waitcnt lgkmcnt(0)
    v_mfma_f32_32x32x16_bf16 v[96:111], v[52:55], v[56:59], v[96:111]
    v_mfma_f32_32x32x16_bf16 v[112:127], v[52:55], v[60:63], v[112:127]
    s_mov_b32 s50, 0x01000100
    s_mov_b32 s51, 0x03020302
    v_mov_b32 v42, 0
    v_mov_b32 v43, 0
    v_mov_b32 v46, 0
    v_mov_b32 v47, 0
    s_mov_b32 s98, 0
    s_branch POLM_29
POL_27:
    global_load_dwordx2 v[20:21], v24, s[46:47] offset:0 sc1
    global_load_dwordx2 v[22:23], v24, s[46:47] offset:256 sc1
    global_load_dwordx2 v[16:17], v25, s[46:47] offset:0 sc1
    global_load_dwordx2 v[18:19], v25, s[46:47] offset:256 sc1
POLM_29:
    s_mov_b64 exec, -1
    s_waitcnt vmcnt(0)
POLN_30:
    v_cmp_ne_u32 vcc, s96, v17
    v_cmp_ne_u32 s[100:101], s96, v19
    s_nop 1
    s_or_b64 vcc, vcc, s[100:101]
    v_cmp_ne_u32 s[100:101], s96, v21
    s_nop 1
    s_or_b64 vcc, vcc, s[100:101]
    v_cmp_ne_u32 s[100:101], s96, v23
    s_nop 1
    s_or_b64 vcc, vcc, s[100:101]
    s_add_u32 s98, s98, 1
    s_cmp_gt_u32 s98, 40000
    s_cbranch_scc1 POLD_28
    s_cmp_eq_u64 vcc, 0
    s_cbranch_scc1 POLD_28
    s_mov_b64 exec, vcc
    s_sleep 2
    s_branch POL_27
POLD_28:
    v_cvt_pk_bf16_f32 v17, v16, v16
    v_lshlrev_b32 v17, 16, v17
    v_sub_f32 v17, v16, v17
    v_cvt_pk_bf16_f32 v32, v16, v17
    v_mov_b32 v33, 0
    v_mov_b32 v34, 0
    v_mov_b32 v35, 0
    v_permlane32_swap_b32 v32, v33
    v_cvt_pk_bf16_f32 v17, v18, v18
    v_lshlrev_b32 v17, 16, v17
    v_sub_f32 v17, v18, v17
    v_cvt_pk_bf16_f32 v36, v18, v17
    v_mov_b32 v37, 0
    v_mov_b32 v38, 0
    v_mov_b32 v39, 0
    v_permlane32_swap_b32 v36, v37
    v_perm_b32 v40, v20, v20, s50
    v_perm_b32 v41, v20, v20, s51
    v_xor_b32 v40, 0x80008000, v40
    v_perm_b32 v44, v22, v22, s50
    v_perm_b32 v45, v22, v22, s51
    v_xor_b32 v44, 0x80008000, v44
    v_mfma_f32_32x32x16_bf16 v[64:79], v[32:35], v[40:43], v[64:79]
    s_nop 0
    v_mfma_f32_32x32x16_bf16 v[80:95], v[32:35], v[44:47], v[80:95]
    v_mfma_f32_32x32x16_bf16 v[96:111], v[36:39], v[40:43], v[96:111]
    v_mfma_f32_32x32x16_bf16 v[112:127], v[36:39], v[44:47], v[112:127]
    v_and_b32 v52, 0xffff0000, v20
    v_rcp_f32 v54, v52
    v_mul_f32 v52, v52, v52
    v_mov_b32 v53, v52
    v_mul_f32 v48, 0xc0135761, v54
    v_mul_f32 v50, v54, v54
    v_mul_f32 v50, v50, v54
    v_mul_f32 v50, 0xbdd2d3e8, v50
    v_mov_b32 v49, v48
    v_mov_b32 v51, v50
    v_and_b32 v60, 0xffff0000, v22
    v_rcp_f32 v62, v60
    v_mul_f32 v60, v60, v60
    v_mov_b32 v61, v60
    v_mul_f32 v56, 0xc0135761, v62
    v_mul_f32 v58, v62, v62
    v_mul_f32 v58, v58, v62
    v_mul_f32 v58, 0xbdd2d3e8, v58
    v_mov_b32 v57, v56
    v_mov_b32 v59, v58
    s_lshl_b32 s54, s8, 2
    s_and_b32 s51, s3, 1
    s_lshl_b32 s51, s51, 1
    s_add_u32 s54, s54, s51
    s_mul_i32 s54, s54, 112
    s_add_u32 s54, s54, s9
    s_lshl_b32 s54, s54, 10
    s_add_u32 s54, s54, 9437184
    v_add_u32 v5, s54, v4
    v_add_u32 v6, 114688, v5
    v_pk_mul_f32 v[8:9], v[64:65], v[64:65]
    v_pk_mul_f32 v[10:11], v[66:67], v[66:67]
    v_pk_mul_f32 v[12:13], v[68:69], v[68:69]
    v_pk_mul_f32 v[14:15], v[70:71], v[70:71]
    v_pk_fma_f32 v[8:9], v[8:9], v[50:51], v[48:49]
    v_pk_fma_f32 v[10:11], v[10:11], v[50:51], v[48:49]
    v_pk_fma_f32 v[12:13], v[12:13], v[50:51], v[48:49]
    v_pk_fma_f32 v[14:15], v[14:15], v[50:51], v[48:49]
    v_pk_mul_f32 v[8:9], v[8:9], v[64:65]
    v_pk_mul_f32 v[10:11], v[10:11], v[66:67]
    v_pk_mul_f32 v[12:13], v[12:13], v[68:69]
    v_pk_mul_f32 v[14:15], v[14:15], v[70:71]
    v_exp_f32 v8, v8
    v_exp_f32 v10, v10
    v_exp_f32 v12, v12
    v_exp_f32 v14, v14
    v_exp_f32 v9, v9
    v_exp_f32 v11, v11
    v_exp_f32 v13, v13
    v_exp_f32 v15, v15
    v_pk_mul_f32 v[64:65], v[64:65], v[72:73]
    v_pk_mul_f32 v[66:67], v[66:67], v[74:75]
    v_pk_mul_f32 v[68:69], v[68:69], v[76:77]
    v_pk_mul_f32 v[70:71], v[70:71], v[78:79]
    v_pk_fma_f32 v[8:9], v[8:9], v[52:53], v[52:53]
    v_pk_fma_f32 v[10:11], v[10:11], v[52:53], v[52:53]
    v_pk_fma_f32 v[12:13], v[12:13], v[52:53], v[52:53]
    v_pk_fma_f32 v[14:15], v[14:15], v[52:53], v[52:53]
    v_rcp_f32 v8, v8
    v_rcp_f32 v10, v10
    v_rcp_f32 v12, v12
    v_rcp_f32 v14, v14
    v_rcp_f32 v9, v9
    v_rcp_f32 v11, v11
    v_rcp_f32 v13, v13
    v_rcp_f32 v15, v15
    v_pk_mul_f32 v[8:9], v[8:9], v[64:65]
    v_pk_mul_f32 v[10:11], v[10:11], v[66:67]
    v_pk_mul_f32 v[12:13], v[12:13], v[68:69]
    v_pk_mul_f32 v[14:15], v[14:15], v[70:71]
    v_cvt_pk_bf16_f32 v128, v8, v9
    v_cvt_pk_bf16_f32 v129, v10, v11
    v_cvt_pk_bf16_f32 v130, v12, v13
    v_cvt_pk_bf16_f32 v131, v14, v15
    global_store_dwordx4 v5, v[128:131], s[46:47] offset:0 sc1
    v_pk_mul_f32 v[8:9], v[80:81], v[80:81]
    v_pk_mul_f32 v[10:11], v[82:83], v[82:83]
    v_pk_mul_f32 v[12:13], v[84:85], v[84:85]
    v_pk_mul_f32 v[14:15], v[86:87], v[86:87]
    v_pk_fma_f32 v[8:9], v[8:9], v[58:59], v[56:57]
    v_pk_fma_f32 v[10:11], v[10:11], v[58:59], v[56:57]
    v_pk_fma_f32 v[12:13], v[12:13], v[58:59], v[56:57]
    v_pk_fma_f32 v[14:15], v[14:15], v[58:59], v[56:57]
    v_pk_mul_f32 v[8:9], v[8:9], v[80:81]
    v_pk_mul_f32 v[10:11], v[10:11], v[82:83]
    v_pk_mul_f32 v[12:13], v[12:13], v[84:85]
    v_pk_mul_f32 v[14:15], v[14:15], v[86:87]
    v_exp_f32 v8, v8
    v_exp_f32 v10, v10
    v_exp_f32 v12, v12
    v_exp_f32 v14, v14
    v_exp_f32 v9, v9
    v_exp_f32 v11, v11
    v_exp_f32 v13, v13
    v_exp_f32 v15, v15
    v_pk_mul_f32 v[80:81], v[80:81], v[88:89]
    v_pk_mul_f32 v[82:83], v[82:83], v[90:91]
    v_pk_mul_f32 v[84:85], v[84:85], v[92:93]
    v_pk_mul_f32 v[86:87], v[86:87], v[94:95]
    v_pk_fma_f32 v[8:9], v[8:9], v[60:61], v[60:61]
    v_pk_fma_f32 v[10:11], v[10:11], v[60:61], v[60:61]
    v_pk_fma_f32 v[12:13], v[12:13], v[60:61], v[60:61]
    v_pk_fma_f32 v[14:15], v[14:15], v[60:61], v[60:61]
    v_rcp_f32 v8, v8
    v_rcp_f32 v10, v10
    v_rcp_f32 v12, v12
    v_rcp_f32 v14, v14
    v_rcp_f32 v9, v9
    v_rcp_f32 v11, v11
    v_rcp_f32 v13, v13
    v_rcp_f32 v15, v15
    v_pk_mul_f32 v[8:9], v[8:9], v[80:81]
    v_pk_mul_f32 v[10:11], v[10:11], v[82:83]
    v_pk_mul_f32 v[12:13], v[12:13], v[84:85]
    v_pk_mul_f32 v[14:15], v[14:15], v[86:87]
    v_cvt_pk_bf16_f32 v132, v8, v9
    v_cvt_pk_bf16_f32 v133, v10, v11
    v_cvt_pk_bf16_f32 v134, v12, v13
    v_cvt_pk_bf16_f32 v135, v14, v15
    global_store_dwordx4 v6, v[132:135], s[46:47] offset:0 sc1
    v_pk_mul_f32 v[8:9], v[96:97], v[96:97]
    v_pk_mul_f32 v[10:11], v[98:99], v[98:99]
    v_pk_mul_f32 v[12:13], v[100:101], v[100:101]
    v_pk_mul_f32 v[14:15], v[102:103], v[102:103]
    v_pk_fma_f32 v[8:9], v[8:9], v[50:51], v[48:49]
    v_pk_fma_f32 v[10:11], v[10:11], v[50:51], v[48:49]
    v_pk_fma_f32 v[12:13], v[12:13], v[50:51], v[48:49]
    v_pk_fma_f32 v[14:15], v[14:15], v[50:51], v[48:49]
    v_pk_mul_f32 v[8:9], v[8:9], v[96:97]
    v_pk_mul_f32 v[10:11], v[10:11], v[98:99]
    v_pk_mul_f32 v[12:13], v[12:13], v[100:101]
    v_pk_mul_f32 v[14:15], v[14:15], v[102:103]
    v_exp_f32 v8, v8
    v_exp_f32 v10, v10
    v_exp_f32 v12, v12
    v_exp_f32 v14, v14
    v_exp_f32 v9, v9
    v_exp_f32 v11, v11
    v_exp_f32 v13, v13
    v_exp_f32 v15, v15
    v_pk_mul_f32 v[96:97], v[96:97], v[104:105]
    v_pk_mul_f32 v[98:99], v[98:99], v[106:107]
    v_pk_mul_f32 v[100:101], v[100:101], v[108:109]
    v_pk_mul_f32 v[102:103], v[102:103], v[110:111]
    v_pk_fma_f32 v[8:9], v[8:9], v[52:53], v[52:53]
    v_pk_fma_f32 v[10:11], v[10:11], v[52:53], v[52:53]
    v_pk_fma_f32 v[12:13], v[12:13], v[52:53], v[52:53]
    v_pk_fma_f32 v[14:15], v[14:15], v[52:53], v[52:53]
    v_rcp_f32 v8, v8
    v_rcp_f32 v10, v10
    v_rcp_f32 v12, v12
    v_rcp_f32 v14, v14
    v_rcp_f32 v9, v9
    v_rcp_f32 v11, v11
    v_rcp_f32 v13, v13
    v_rcp_f32 v15, v15
    v_pk_mul_f32 v[8:9], v[8:9], v[96:97]
    v_pk_mul_f32 v[10:11], v[10:11], v[98:99]
    v_pk_mul_f32 v[12:13], v[12:13], v[100:101]
    v_pk_mul_f32 v[14:15], v[14:15], v[102:103]
    v_cvt_pk_bf16_f32 v128, v8, v9
    v_cvt_pk_bf16_f32 v129, v10, v11
    v_cvt_pk_bf16_f32 v130, v12, v13
    v_cvt_pk_bf16_f32 v131, v14, v15
    global_store_dwordx4 v5, v[128:131], s[46:47] offset:1024 sc1
    v_pk_mul_f32 v[8:9], v[112:113], v[112:113]
    v_pk_mul_f32 v[10:11], v[114:115], v[114:115]
    v_pk_mul_f32 v[12:13], v[116:117], v[116:117]
    v_pk_mul_f32 v[14:15], v[118:119], v[118:119]
    v_pk_fma_f32 v[8:9], v[8:9], v[58:59], v[56:57]
    v_pk_fma_f32 v[10:11], v[10:11], v[58:59], v[56:57]
    v_pk_fma_f32 v[12:13], v[12:13], v[58:59], v[56:57]
    v_pk_fma_f32 v[14:15], v[14:15], v[58:59], v[56:57]
    v_pk_mul_f32 v[8:9], v[8:9], v[112:113]
    v_pk_mul_f32 v[10:11], v[10:11], v[114:115]
    v_pk_mul_f32 v[12:13], v[12:13], v[116:117]
    v_pk_mul_f32 v[14:15], v[14:15], v[118:119]
    v_exp_f32 v8, v8
    v_exp_f32 v10, v10
    v_exp_f32 v12, v12
    v_exp_f32 v14, v14
    v_exp_f32 v9, v9
    v_exp_f32 v11, v11
    v_exp_f32 v13, v13
    v_exp_f32 v15, v15
    v_pk_mul_f32 v[112:113], v[112:113], v[120:121]
    v_pk_mul_f32 v[114:115], v[114:115], v[122:123]
    v_pk_mul_f32 v[116:117], v[116:117], v[124:125]
    v_pk_mul_f32 v[118:119], v[118:119], v[126:127]
    v_pk_fma_f32 v[8:9], v[8:9], v[60:61], v[60:61]
    v_pk_fma_f32 v[10:11], v[10:11], v[60:61], v[60:61]
    v_pk_fma_f32 v[12:13], v[12:13], v[60:61], v[60:61]
    v_pk_fma_f32 v[14:15], v[14:15], v[60:61], v[60:61]
    v_rcp_f32 v8, v8
    v_rcp_f32 v10, v10
    v_rcp_f32 v12, v12
    v_rcp_f32 v14, v14
    v_rcp_f32 v9, v9
    v_rcp_f32 v11, v11
    v_rcp_f32 v13, v13
    v_rcp_f32 v15, v15
    v_pk_mul_f32 v[8:9], v[8:9], v[112:113]
    v_pk_mul_f32 v[10:11], v[10:11], v[114:115]
    v_pk_mul_f32 v[12:13], v[12:13], v[116:117]
    v_pk_mul_f32 v[14:15], v[14:15], v[118:119]
    v_cvt_pk_bf16_f32 v132, v8, v9
    v_cvt_pk_bf16_f32 v133, v10, v11
    v_cvt_pk_bf16_f32 v134, v12, v13
    v_cvt_pk_bf16_f32 v135, v14, v15
    global_store_dwordx4 v6, v[132:135], s[46:47] offset:1024 sc1
    s_waitcnt vmcnt(0)
    global_load_dwordx4 v[32:35], v5, s[46:47] offset:0
    global_load_dwordx4 v[36:39], v6, s[46:47] offset:0
    global_load_dwordx4 v[40:43], v5, s[46:47] offset:1024
    global_load_dwordx4 v[44:47], v6, s[46:47] offset:1024
    s_branch P3_END2
    s_branch P3_END
STATS_WG:
    s_sub_u32 s6, s2, 224
    s_lshr_b32 s7, s6, 1
    s_lshl_b32 s7, s7, 17
    s_and_b32 s8, s6, 1
    s_lshl_b32 s8, s8, 7
    s_add_u32 s7, s7, s8
    s_lshl_b32 s8, s3, 11
    s_add_u32 s7, s7, s8
    s_add_u32 s7, s7, 7340032
    v_lshrrev_b32 v2, 3, v0
    v_lshlrev_b32 v2, 8, v2
    v_and_b32 v3, 7, v0
    v_lshl_add_u32 v2, v3, 4, v2
    v_add_u32 v2, s7, v2
    global_load_dwordx4 v[32:35], v2, s[46:47] sc1
    v_add_u32 v2, 0x4000, v2
    global_load_dwordx4 v[36:39], v2, s[46:47] sc1
    v_add_u32 v2, 0x4000, v2
    global_load_dwordx4 v[40:43], v2, s[46:47] sc1
    v_add_u32 v2, 0x4000, v2
    global_load_dwordx4 v[44:47], v2, s[46:47] sc1
    v_add_u32 v2, 0x4000, v2
    global_load_dwordx4 v[48:51], v2, s[46:47] sc1
    v_add_u32 v2, 0x4000, v2
    global_load_dwordx4 v[52:55], v2, s[46:47] sc1
    v_add_u32 v2, 0x4000, v2
    global_load_dwordx4 v[56:59], v2, s[46:47] sc1
    v_add_u32 v2, 0x4000, v2
    global_load_dwordx4 v[60:63], v2, s[46:47] sc1
    s_and_b32 s7, s3, 3
    s_lshl_b32 s7, s7, 6
    v_add_u32 v6, s7, v0
    v_min_u32 v6, 223, v6
    s_mul_i32 s7, s6, 224
    v_add_u32 v6, s7, v6
    v_lshlrev_b32 v7, 2, v6
    v_add_u32 v7, 131072, v7
    v_lshlrev_b32 v6, 3, v6
    v_add_u32 v6, 393216, v6
    global_load_dword v80, v7, s[46:47] sc1
    v_add_u32 v7, 28672, v7
    global_load_dword v81, v7, s[46:47] sc1
    v_add_u32 v7, 28672, v7
    global_load_dword v82, v7, s[46:47] sc1
    v_add_u32 v7, 28672, v7
    global_load_dword v83, v7, s[46:47] sc1
    v_add_u32 v7, 28672, v7
    global_load_dword v84, v7, s[46:47] sc1
    v_add_u32 v7, 28672, v7
    global_load_dword v85, v7, s[46:47] sc1
    v_add_u32 v7, 28672, v7
    global_load_dword v86, v7, s[46:47] sc1
    v_add_u32 v7, 28672, v7
    global_load_dword v87, v7, s[46:47] sc1
    global_load_dwordx4 v[144:147], v30, s[46:47] offset:0 sc1
    global_load_dwordx4 v[148:151], v31, s[46:47] offset:0 sc1
    global_load_dwordx4 v[152:155], v30, s[46:47] offset:1024 sc1
    global_load_dwordx4 v[156:159], v31, s[46:47] offset:1024 sc1
    global_load_dwordx4 v[160:163], v30, s[46:47] offset:2048 sc1
    global_load_dwordx4 v[164:167], v31, s[46:47] offset:2048 sc1
    global_load_dwordx4 v[168:171], v30, s[46:47] offset:3072 sc1
    v_add_u32 v30, 4096, v30
    global_load_dwordx4 v[172:175], v31, s[46:47] offset:3072 sc1
    v_add_u32 v31, 4096, v31
    global_load_dwordx4 v[176:179], v30, s[46:47] offset:0 sc1
    global_load_dwordx4 v[180:183], v31, s[46:47] offset:0 sc1
    global_load_dwordx4 v[184:187], v30, s[46:47] offset:1024 sc1
    global_load_dwordx4 v[188:191], v31, s[46:47] offset:1024 sc1
    global_load_dwordx4 v[192:195], v30, s[46:47] offset:2048 sc1
    global_load_dwordx4 v[196:199], v31, s[46:47] offset:2048 sc1
    global_load_dwordx4 v[200:203], v30, s[46:47] offset:3072 sc1
    v_add_u32 v30, 4096, v30
    global_load_dwordx4 v[204:207], v31, s[46:47] offset:3072 sc1
    v_add_u32 v31, 4096, v31
    global_load_dwordx4 v[208:211], v30, s[46:47] offset:0 sc1
    global_load_dwordx4 v[212:215], v31, s[46:47] offset:0 sc1
    global_load_dwordx4 v[216:219], v30, s[46:47] offset:1024 sc1
    global_load_dwordx4 v[220:223], v31, s[46:47] offset:1024 sc1
    global_load_dwordx4 v[224:227], v30, s[46:47] offset:2048 sc1
    global_load_dwordx4 v[228:231], v31, s[46:47] offset:2048 sc1
    global_load_dwordx4 v[232:235], v30, s[46:47] offset:3072 sc1
    v_add_u32 v30, 4096, v30
    global_load_dwordx4 v[236:239], v31, s[46:47] offset:3072 sc1
    v_add_u32 v31, 4096, v31
    global_load_dwordx4 v[240:243], v30, s[46:47] offset:0 sc1
    global_load_dwordx4 v[244:247], v31, s[46:47] offset:0 sc1
    global_load_dwordx4 v[248:251], v30, s[46:47] offset:1024 sc1
    global_load_dwordx4 v[252:255], v31, s[46:47] offset:1024 sc1
    v_mov_b32 v64, 0
    v_mov_b32 v65, 0
    v_mov_b32 v66, 0
    v_mov_b32 v67, 0
    v_mov_b32 v68, 0
    v_mov_b32 v69, 0
    v_mov_b32 v70, 0
    v_mov_b32 v71, 0
    v_mov_b32 v72, 0
    v_mov_b32 v73, 0
    v_mov_b32 v74, 0
    v_mov_b32 v75, 0
    v_mov_b32 v76, 0
    v_mov_b32 v77, 0
    v_mov_b32 v78, 0
    v_mov_b32 v79, 0
    s_waitcnt vmcnt(43)
    v_lshlrev_b32 v4, 16, v32
    v_and_b32 v5, 0xffff0000, v32
    v_add_f32 v64, v64, v4
    v_add_f32 v65, v65, v5
    v_fmac_f32 v72, v4, v4
    v_fmac_f32 v73, v5, v5
    v_lshlrev_b32 v4, 16, v33
    v_and_b32 v5, 0xffff0000, v33
    v_add_f32 v66, v66, v4
    v_add_f32 v67, v67, v5
    v_fmac_f32 v74, v4, v4
    v_fmac_f32 v75, v5, v5
    v_lshlrev_b32 v4, 16, v34
    v_and_b32 v5, 0xffff0000, v34
    v_add_f32 v68, v68, v4
    v_add_f32 v69, v69, v5
    v_fmac_f32 v76, v4, v4
    v_fmac_f32 v77, v5, v5
    v_lshlrev_b32 v4, 16, v35
    v_and_b32 v5, 0xffff0000, v35
    v_add_f32 v70, v70, v4
    v_add_f32 v71, v71, v5
    v_fmac_f32 v78, v4, v4
    v_fmac_f32 v79, v5, v5
    s_waitcnt vmcnt(42)
    v_lshlrev_b32 v4, 16, v36
    v_and_b32 v5, 0xffff0000, v36
    v_add_f32 v64, v64, v4
    v_add_f32 v65, v65, v5
    v_fmac_f32 v72, v4, v4
    v_fmac_f32 v73, v5, v5
    v_lshlrev_b32 v4, 16, v37
    v_and_b32 v5, 0xffff0000, v37
    v_add_f32 v66, v66, v4
    v_add_f32 v67, v67, v5
    v_fmac_f32 v74, v4, v4
    v_fmac_f32 v75, v5, v5
    v_lshlrev_b32 v4, 16, v38
    v_and_b32 v5, 0xffff0000, v38
    v_add_f32 v68, v68, v4
    v_add_f32 v69, v69, v5
    v_fmac_f32 v76, v4, v4
    v_fmac_f32 v77, v5, v5
    v_lshlrev_b32 v4, 16, v39
    v_and_b32 v5, 0xffff0000, v39
    v_add_f32 v70, v70, v4
    v_add_f32 v71, v71, v5
    v_fmac_f32 v78, v4, v4
    v_fmac_f32 v79, v5, v5
    s_waitcnt vmcnt(41)
    v_lshlrev_b32 v4, 16, v40
    v_and_b32 v5, 0xffff0000, v40
    v_add_f32 v64, v64, v4
    v_add_f32 v65, v65, v5
    v_fmac_f32 v72, v4, v4
    v_fmac_f32 v73, v5, v5
    v_lshlrev_b32 v4, 16, v41
    v_and_b32 v5, 0xffff0000, v41
    v_add_f32 v66, v66, v4
    v_add_f32 v67, v67, v5
    v_fmac_f32 v74, v4, v4
    v_fmac_f32 v75, v5, v5
    v_lshlrev_b32 v4, 16, v42
    v_and_b32 v5, 0xffff0000, v42
    v_add_f32 v68, v68, v4
    v_add_f32 v69, v69, v5
    v_fmac_f32 v76, v4, v4
    v_fmac_f32 v77, v5, v5
    v_lshlrev_b32 v4, 16, v43
    v_and_b32 v5, 0xffff0000, v43
    v_add_f32 v70, v70, v4
    v_add_f32 v71, v71, v5
    v_fmac_f32 v78, v4, v4
    v_fmac_f32 v79, v5, v5
    s_waitcnt vmcnt(40)
    v_lshlrev_b32 v4, 16, v44
    v_and_b32 v5, 0xffff0000, v44
    v_add_f32 v64, v64, v4
    v_add_f32 v65, v65, v5
    v_fmac_f32 v72, v4, v4
    v_fmac_f32 v73, v5, v5
    v_lshlrev_b32 v4, 16, v45
    v_and_b32 v5, 0xffff0000, v45
    v_add_f32 v66, v66, v4
    v_add_f32 v67, v67, v5
    v_fmac_f32 v74, v4, v4
    v_fmac_f32 v75, v5, v5
    v_lshlrev_b32 v4, 16, v46
    v_and_b32 v5, 0xffff0000, v46
    v_add_f32 v68, v68, v4
    v_add_f32 v69, v69, v5
    v_fmac_f32 v76, v4, v4
    v_fmac_f32 v77, v5, v5
    v_lshlrev_b32 v4, 16, v47
    v_and_b32 v5, 0xffff0000, v47
    v_add_f32 v70, v70, v4
    v_add_f32 v71, v71, v5
    v_fmac_f32 v78, v4, v4
    v_fmac_f32 v79, v5, v5
    s_waitcnt vmcnt(39)
    v_lshlrev_b32 v4, 16, v48
    v_and_b32 v5, 0xffff0000, v48
    v_add_f32 v64, v64, v4
    v_add_f32 v65, v65, v5
    v_fmac_f32 v72, v4, v4
    v_fmac_f32 v73, v5, v5
    v_lshlrev_b32 v4, 16, v49
    v_and_b32 v5, 0xffff0000, v49
    v_add_f32 v66, v66, v4
    v_add_f32 v67, v67, v5
    v_fmac_f32 v74, v4, v4
    v_fmac_f32 v75, v5, v5
    v_lshlrev_b32 v4, 16, v50
    v_and_b32 v5, 0xffff0000, v50
    v_add_f32 v68, v68, v4
    v_add_f32 v69, v69, v5
    v_fmac_f32 v76, v4, v4
    v_fmac_f32 v77, v5, v5
    v_lshlrev_b32 v4, 16, v51
    v_and_b32 v5, 0xffff0000, v51
    v_add_f32 v70, v70, v4
    v_add_f32 v71, v71, v5
    v_fmac_f32 v78, v4, v4
    v_fmac_f32 v79, v5, v5
    s_waitcnt vmcnt(38)
    v_lshlrev_b32 v4, 16, v52
    v_and_b32 v5, 0xffff0000, v52
    v_add_f32 v64, v64, v4
    v_add_f32 v65, v65, v5
    v_fmac_f32 v72, v4, v4
    v_fmac_f32 v73, v5, v5
    v_lshlrev_b32 v4, 16, v53
    v_and_b32 v5, 0xffff0000, v53
    v_add_f32 v66, v66, v4
    v_add_f32 v67, v67, v5
    v_fmac_f32 v74, v4, v4
    v_fmac_f32 v75, v5, v5
    v_lshlrev_b32 v4, 16, v54
    v_and_b32 v5, 0xffff0000, v54
    v_add_f32 v68, v68, v4
    v_add_f32 v69, v69, v5
    v_fmac_f32 v76, v4, v4
    v_fmac_f32 v77, v5, v5
    v_lshlrev_b32 v4, 16, v55
    v_and_b32 v5, 0xffff0000, v55
    v_add_f32 v70, v70, v4
    v_add_f32 v71, v71, v5
    v_fmac_f32 v78, v4, v4
    v_fmac_f32 v79, v5, v5
    s_waitcnt vmcnt(37)
    v_lshlrev_b32 v4, 16, v56
    v_and_b32 v5, 0xffff0000, v56
    v_add_f32 v64, v64, v4
    v_add_f32 v65, v65, v5
    v_fmac_f32 v72, v4, v4
    v_fmac_f32 v73, v5, v5
    v_lshlrev_b32 v4, 16, v57
    v_and_b32 v5, 0xffff0000, v57
    v_add_f32 v66, v66, v4
    v_add_f32 v67, v67, v5
    v_fmac_f32 v74, v4, v4
    v_fmac_f32 v75, v5, v5
    v_lshlrev_b32 v4, 16, v58
    v_and_b32 v5, 0xffff0000, v58
    v_add_f32 v68, v68, v4
    v_add_f32 v69, v69, v5
    v_fmac_f32 v76, v4, v4
    v_fmac_f32 v77, v5, v5
    v_lshlrev_b32 v4, 16, v59
    v_and_b32 v5, 0xffff0000, v59
    v_add_f32 v70, v70, v4
    v_add_f32 v71, v71, v5
    v_fmac_f32 v78, v4, v4
    v_fmac_f32 v79, v5, v5
    s_waitcnt vmcnt(36)
    v_lshlrev_b32 v4, 16, v60
    v_and_b32 v5, 0xffff0000, v60
    v_add_f32 v64, v64, v4
    v_add_f32 v65, v65, v5
    v_fmac_f32 v72, v4, v4
    v_fmac_f32 v73, v5, v5
    v_lshlrev_b32 v4, 16, v61
    v_and_b32 v5, 0xffff0000, v61
    v_add_f32 v66, v66, v4
    v_add_f32 v67, v67, v5
    v_fmac_f32 v74, v4, v4
    v_fmac_f32 v75, v5, v5
    v_lshlrev_b32 v4, 16, v62
    v_and_b32 v5, 0xffff0000, v62
    v_add_f32 v68, v68, v4
    v_add_f32 v69, v69, v5
    v_fmac_f32 v76, v4, v4
    v_fmac_f32 v77, v5, v5
    v_lshlrev_b32 v4, 16, v63
    v_and_b32 v5, 0xffff0000, v63
    v_add_f32 v70, v70, v4
    v_add_f32 v71, v71, v5
    v_fmac_f32 v78, v4, v4
    v_fmac_f32 v79, v5, v5
    s_waitcnt vmcnt(28)
    v_add_f32 v80, v80, v81
    v_add_f32 v80, v80, v82
    v_add_f32 v80, v80, v83
    v_add_f32 v80, v80, v84
    v_add_f32 v80, v80, v85
    v_add_f32 v80, v80, v86
    v_add_f32 v80, v80, v87
    v_mov_b32 v81, s96
    global_store_dwordx2 v6, v[80:81], s[46:47] sc1
    s_lshl_b32 s7, s3, 12
    v_lshlrev_b32 v4, 6, v0
    v_add_u32 v4, s7, v4
    ds_write_b128 v4, v[64:67] offset:0
    ds_write_b128 v4, v[68:71] offset:16
    ds_write_b128 v4, v[72:75] offset:32
    ds_write_b128 v4, v[76:79] offset:48
    s_waitcnt lgkmcnt(0)
    s_barrier
    v_lshrrev_b32 v5, 3, v0
    v_lshlrev_b32 v5, 6, v5
    v_and_b32 v6, 7, v0
    v_lshl_add_u32 v5, v6, 2, v5
    v_add_u32 v5, s7, v5
    ds_read2_b32 v[32:33], v5 offset0:0 offset1:8
    ds_read2_b32 v[34:35], v5 offset0:128 offset1:136
    v_add_u32 v5, 1024, v5
    ds_read2_b32 v[36:37], v5 offset0:0 offset1:8
    ds_read2_b32 v[38:39], v5 offset0:128 offset1:136
    v_add_u32 v5, 1024, v5
    ds_read2_b32 v[40:41], v5 offset0:0 offset1:8
    ds_read2_b32 v[42:43], v5 offset0:128 offset1:136
    v_add_u32 v5, 1024, v5
    ds_read2_b32 v[44:45], v5 offset0:0 offset1:8
    ds_read2_b32 v[46:47], v5 offset0:128 offset1:136
    v_add_u32 v5, 1024, v5
    s_waitcnt lgkmcnt(0)
    v_add_f32 v32, v32, v34
    v_add_f32 v33, v33, v35
    v_add_f32 v32, v32, v36
    v_add_f32 v33, v33, v37
    v_add_f32 v32, v32, v38
    v_add_f32 v33, v33, v39
    v_add_f32 v32, v32, v40
    v_add_f32 v33, v33, v41
    v_add_f32 v32, v32, v42
    v_add_f32 v33, v33, v43
    v_add_f32 v32, v32, v44
    v_add_f32 v33, v33, v45
    v_add_f32 v32, v32, v46
    v_add_f32 v33, v33, v47
    s_lshl_b32 s7, s3, 9
    s_add_u32 s7, s7, 118784
    v_lshlrev_b32 v5, 3, v0
    v_add_u32 v6, s7, v5
    ds_write_b64 v6, v[32:33]
    s_waitcnt lgkmcnt(0)
    s_barrier
    s_cmp_eq_u32 s3, 0
    s_cbranch_scc0 STATS_done
    v_add_u32 v6, 118784, v5
    ds_read_b64 v[32:33], v6 offset:0
    ds_read_b64 v[34:35], v6 offset:512
    ds_read_b64 v[36:37], v6 offset:1024
    ds_read_b64 v[38:39], v6 offset:1536
    ds_read_b64 v[40:41], v6 offset:2048
    ds_read_b64 v[42:43], v6 offset:2560
    ds_read_b64 v[44:45], v6 offset:3072
    ds_read_b64 v[46:47], v6 offset:3584
    s_waitcnt lgkmcnt(0)
    v_add_f32 v32, v32, v34
    v_add_f32 v33, v33, v35
    v_add_f32 v32, v32, v36
    v_add_f32 v33, v33, v37
    v_add_f32 v32, v32, v38
    v_add_f32 v33, v33, v39
    v_add_f32 v32, v32, v40
    v_add_f32 v33, v33, v41
    v_add_f32 v32, v32, v42
    v_add_f32 v33, v33, v43
    v_add_f32 v32, v32, v44
    v_add_f32 v33, v33, v45
    v_add_f32 v32, v32, v46
    v_add_f32 v33, v33, v47
    v_mul_f32 v32, 0x3b000000, v32
    v_mul_f32 v33, 0x3b000000, v33
    v_fma_f32 v33, -v32, v32, v33
    v_max_f32 v33, 0, v33
    v_cvt_pk_bf16_f32 v33, v33, v33
    v_lshlrev_b32 v33, 16, v33
    v_add_f32 v33, 0x3727c5ac, v33
    v_cvt_pk_bf16_f32 v33, v33, v33
    v_lshlrev_b32 v33, 16, v33
    v_sqrt_f32 v33, v33
    s_nop 0
    v_cvt_pk_bf16_f32 v34, v32, v33
    v_mov_b32 v35, s96
    s_lshl_b32 s7, s6, 9
    s_add_u32 s7, s7, 16384
    v_add_u32 v6, s7, v5
    global_store_dwordx2 v6, v[34:35], s[46:47] sc1
STATS_done:
P3_END:
    s_waitcnt vmcnt(0)
P3_END2:
    s_barrier
    s_cmp_eq_u32 s3, 7
    s_cbranch_scc0 FS_31
    s_lshl_b32 s4, s2, 6
    s_add_u32 s4, s4, 49152
    v_mov_b32 v1, s4
    v_mov_b32 v2, s96
    s_mov_b64 exec, 1
    global_store_dword v1, v2, s[46:47] sc1
    s_mov_b64 exec, -1
    s_lshr_b32 s6, s10, 1
    s_lshr_b32 s7, s6, 2
    s_lshl_b32 s7, s7, 1
    s_and_b32 s6, s6, 3
    s_mul_i32 s6, s6, 56
    s_add_u32 s6, s6, s7
    v_min_u32 v4, 13, v0
    v_lshrrev_b32 v5, 1, v4
    v_and_b32 v4, 1, v4
    v_lshl_add_u32 v4, v5, 3, v4
    v_add_u32 v4, s6, v4
    v_lshlrev_b32 v3, 6, v4
    v_add_u32 v3, 49152, v3
    s_mov_b32 s98, 0
POL_32:
    global_load_dword v4, v3, s[46:47] offset:0 sc1
POLM_34:
    s_mov_b64 exec, -1
    s_waitcnt vmcnt(0)
POLN_35:
    v_cmp_ne_u32 vcc, s96, v4
    s_add_u32 s98, s98, 1
    s_cmp_gt_u32 s98, 40000
    s_cbranch_scc1 POLD_33
    s_cmp_eq_u64 vcc, 0
    s_cbranch_scc1 POLD_33
    s_mov_b64 exec, vcc
    s_sleep 2
    s_branch POL_32
POLD_33:
FS_31:
    s_barrier
    s_waitcnt vmcnt(0)
    s_mul_i32 s6, s99, 14336
    s_mul_i32 s7, s10, 229376
    s_add_u32 s7, s7, s6
    s_add_u32 s7, s7, 9437184
    v_lshlrev_b32 v1, 4, v0
    v_add_u32 v2, s7, v1
    v_add_u32 v3, 114688, v2
    global_load_dwordx4 v[16:19], v2, s[46:47] offset:0 sc1
    global_load_dwordx4 v[20:23], v3, s[46:47] offset:0 sc1
    global_load_dwordx4 v[24:27], v2, s[46:47] offset:1024 sc1
    global_load_dwordx4 v[28:31], v3, s[46:47] offset:1024 sc1
    global_load_dwordx4 v[32:35], v2, s[46:47] offset:2048 sc1
    global_load_dwordx4 v[36:39], v3, s[46:47] offset:2048 sc1
    global_load_dwordx4 v[40:43], v2, s[46:47] offset:3072 sc1
    global_load_dwordx4 v[44:47], v3, s[46:47] offset:3072 sc1
    v_add_u32 v2, 4096, v2
    v_add_u32 v3, 4096, v3
    global_load_dwordx4 v[48:51], v2, s[46:47] offset:0 sc1
    global_load_dwordx4 v[52:55], v3, s[46:47] offset:0 sc1
    global_load_dwordx4 v[56:59], v2, s[46:47] offset:1024 sc1
    global_load_dwordx4 v[60:63], v3, s[46:47] offset:1024 sc1
    global_load_dwordx4 v[128:131], v2, s[46:47] offset:2048 sc1
    global_load_dwordx4 v[132:135], v3, s[46:47] offset:2048 sc1
    global_load_dwordx4 v[136:139], v2, s[46:47] offset:3072 sc1
    global_load_dwordx4 v[140:143], v3, s[46:47] offset:3072 sc1
    v_add_u32 v2, 4096, v2
    v_add_u32 v3, 4096, v3
    s_lshl_b32 s15, s10, 6
    s_lshl_b32 s12, s3, 3
    s_add_u32 s15, s15, s12
    v_lshrrev_b32 v6, 3, v0
    v_and_b32 v7, 7, v0
    s_lshr_b32 s48, s15, 7
    s_lshl_b32 s48, s48, 17
    s_and_b32 s49, s15, 127
    s_lshl_b32 s49, s49, 1
    s_add_u32 s48, s48, s49
    s_lshl_b32 s49, s11, 14
    s_add_u32 s48, s48, s49
    s_add_u32 s48, s48, 7340032
    s_sub_u32 s48, s48, s12
    s_sub_u32 s48, s48, s12
    s_lshl_b32 s49, s3, 11
    s_add_u32 s48, s48, s49
    v_lshlrev_b32 v8, 8, v6
    v_lshl_add_u32 v8, v7, 4, v8
    v_add_u32 v8, s48, v8
    s_mul_i32 s48, s3, 1040
    s_add_u32 s48, s48, 140288
    v_add_u32 v4, s48, v1
    v_mul_u32_u24 v5, 1040, v7
    v_lshl_add_u32 v5, v6, 1, v5
    s_lshl_b32 s48, s12, 1
    s_add_u32 s48, s48, 140288
    v_add_u32 v5, s48, v5
    s_lshl_b32 s48, s11, 7
    s_add_u32 s48, s48, 65536
    v_lshlrev_b32 v9, 4, v7
    v_add_u32 v9, s48, v9
    s_lshl_b32 s48, s15, 10
    s_lshl_b32 s49, s11, 7
    s_add_u32 s48, s48, s49
    v_lshlrev_b32 v10, 10, v6
    v_lshl_add_u32 v10, v7, 4, v10
    v_add_u32 v10, s48, v10
    s_mul_i32 s48, s99, 2176
    v_add_u32 v11, s48, v1
    v_add_u32 v12, 70144, v11
    v_lshrrev_b32 v13, 2, v7
    v_mul_u32_u24 v13, 70144, v13
    v_bfe_u32 v14, v7, 1, 1
    v_mul_u32_u24 v14, 17536, v14
    v_and_b32 v15, 1, v7
    v_mul_u32_u24 v15, 1088, v15
    v_add3_u32 v13, v13, v14, v15
    s_lshr_b32 s48, s3, 2
    s_mul_i32 s48, s48, 35072
    s_and_b32 s49, s3, 3
    s_lshl_b32 s49, s49, 7
    s_add_u32 s48, s48, s49
    v_lshl_add_u32 v13, v6, 4, v13
    v_add_u32 v13, s48, v13
    s_waitcnt vmcnt(14)
    v_mfma_f32_32x32x16_bf16 v[64:79], v[144:147], v[16:19], 0
    v_mfma_f32_32x32x16_bf16 v[80:95], v[144:147], v[20:23], 0
    v_mfma_f32_32x32x16_bf16 v[96:111], v[148:151], v[16:19], 0
    v_mfma_f32_32x32x16_bf16 v[112:127], v[148:151], v[20:23], 0
    global_load_dwordx4 v[16:19], v2, s[46:47] offset:0 sc1
    global_load_dwordx4 v[20:23], v3, s[46:47] offset:0 sc1
    s_waitcnt vmcnt(14)
    v_mfma_f32_32x32x16_bf16 v[64:79], v[152:155], v[24:27], v[64:79]
    v_mfma_f32_32x32x16_bf16 v[80:95], v[152:155], v[28:31], v[80:95]
    v_mfma_f32_32x32x16_bf16 v[96:111], v[156:159], v[24:27], v[96:111]
    v_mfma_f32_32x32x16_bf16 v[112:127], v[156:159], v[28:31], v[112:127]
    global_load_dwordx4 v[24:27], v2, s[46:47] offset:1024 sc1
    global_load_dwordx4 v[28:31], v3, s[46:47] offset:1024 sc1
    s_waitcnt vmcnt(14)
    v_mfma_f32_32x32x16_bf16 v[64:79], v[160:163], v[32:35], v[64:79]
    v_mfma_f32_32x32x16_bf16 v[80:95], v[160:163], v[36:39], v[80:95]
    v_mfma_f32_32x32x16_bf16 v[96:111], v[164:167], v[32:35], v[96:111]
    v_mfma_f32_32x32x16_bf16 v[112:127], v[164:167], v[36:39], v[112:127]
    global_load_dwordx4 v[32:35], v2, s[46:47] offset:2048 sc1
    global_load_dwordx4 v[36:39], v3, s[46:47] offset:2048 sc1
    s_waitcnt vmcnt(14)
    v_mfma_f32_32x32x16_bf16 v[64:79], v[168:171], v[40:43], v[64:79]
    v_mfma_f32_32x32x16_bf16 v[80:95], v[168:171], v[44:47], v[80:95]
    v_mfma_f32_32x32x16_bf16 v[96:111], v[172:175], v[40:43], v[96:111]
    v_mfma_f32_32x32x16_bf16 v[112:127], v[172:175], v[44:47], v[112:127]
    global_load_dwordx4 v[40:43], v2, s[46:47] offset:3072 sc1
    global_load_dwordx4 v[44:47], v3, s[46:47] offset:3072 sc1
    v_add_u32 v2, 4096, v2
    v_add_u32 v3, 4096, v3
    s_waitcnt vmcnt(14)
    v_mfma_f32_32x32x16_bf16 v[64:79], v[176:179], v[48:51], v[64:79]
    v_mfma_f32_32x32x16_bf16 v[80:95], v[176:179], v[52:55], v[80:95]
    v_mfma_f32_32x32x16_bf16 v[96:111], v[180:183], v[48:51], v[96:111]
    v_mfma_f32_32x32x16_bf16 v[112:127], v[180:183], v[52:55], v[112:127]
    global_load_dwordx4 v[48:51], v2, s[46:47] offset:0 sc1
    global_load_dwordx4 v[52:55], v3, s[46:47] offset:0 sc1
    s_waitcnt vmcnt(14)
    v_mfma_f32_32x32x16_bf16 v[64:79], v[184:187], v[56:59], v[64:79]
    v_mfma_f32_32x32x16_bf16 v[80:95], v[184:187], v[60:63], v[80:95]
    v_mfma_f32_32x32x16_bf16 v[96:111], v[188:191], v[56:59], v[96:111]
    v_mfma_f32_32x32x16_bf16 v[112:127], v[188:191], v[60:63], v[112:127]
    global_load_dwordx4 v[56:59], v2, s[46:47] offset:1024 sc1
    global_load_dwordx4 v[60:63], v3, s[46:47] offset:1024 sc1
    s_waitcnt vmcnt(14)
    v_mfma_f32_32x32x16_bf16 v[64:79], v[192:195], v[128:131], v[64:79]
    v_mfma_f32_32x32x16_bf16 v[80:95], v[192:195], v[132:135], v[80:95]
    v_mfma_f32_32x32x16_bf16 v[96:111], v[196:199], v[128:131], v[96:111]
    v_mfma_f32_32x32x16_bf16 v[112:127], v[196:199], v[132:135], v[112:127]
    global_load_dwordx4 v[144:147], v9, s[46:47] sc1
    global_load_dwordx4 v[148:151], v8, s[46:47] sc1
    s_waitcnt vmcnt(14)
    v_mfma_f32_32x32x16_bf16 v[64:79], v[200:203], v[136:139], v[64:79]
    v_mfma_f32_32x32x16_bf16 v[80:95], v[200:203], v[140:143], v[80:95]
    v_mfma_f32_32x32x16_bf16 v[96:111], v[204:207], v[136:139], v[96:111]
    v_mfma_f32_32x32x16_bf16 v[112:127], v[204:207], v[140:143], v[112:127]
    s_waitcnt vmcnt(12)
    v_mfma_f32_32x32x16_bf16 v[64:79], v[208:211], v[16:19], v[64:79]
    v_mfma_f32_32x32x16_bf16 v[80:95], v[208:211], v[20:23], v[80:95]
    v_mfma_f32_32x32x16_bf16 v[96:111], v[212:215], v[16:19], v[96:111]
    v_mfma_f32_32x32x16_bf16 v[112:127], v[212:215], v[20:23], v[112:127]
    s_waitcnt vmcnt(10)
    v_mfma_f32_32x32x16_bf16 v[64:79], v[216:219], v[24:27], v[64:79]
    v_mfma_f32_32x32x16_bf16 v[80:95], v[216:219], v[28:31], v[80:95]
    v_mfma_f32_32x32x16_bf16 v[96:111], v[220:223], v[24:27], v[96:111]
    v_mfma_f32_32x32x16_bf16 v[112:127], v[220:223], v[28:31], v[112:127]
    s_waitcnt vmcnt(8)
    v_mfma_f32_32x32x16_bf16 v[64:79], v[224:227], v[32:35], v[64:79]
    v_mfma_f32_32x32x16_bf16 v[80:95], v[224:227], v[36:39], v[80:95]
    v_mfma_f32_32x32x16_bf16 v[96:111], v[228:231], v[32:35], v[96:111]
    v_mfma_f32_32x32x16_bf16 v[112:127], v[228:231], v[36:39], v[112:127]
    s_waitcnt vmcnt(6)
    v_mfma_f32_32x32x16_bf16 v[64:79], v[232:235], v[40:43], v[64:79]
    v_mfma_f32_32x32x16_bf16 v[80:95], v[232:235], v[44:47], v[80:95]
    v_mfma_f32_32x32x16_bf16 v[96:111], v[236:239], v[40:43], v[96:111]
    v_mfma_f32_32x32x16_bf16 v[112:127], v[236:239], v[44:47], v[112:127]
    s_waitcnt vmcnt(4)
    v_mfma_f32_32x32x16_bf16 v[64:79], v[240:243], v[48:51], v[64:79]
    v_mfma_f32_32x32x16_bf16 v[80:95], v[240:243], v[52:55], v[80:95]
    v_mfma_f32_32x32x16_bf16 v[96:111], v[244:247], v[48:51], v[96:111]
    v_mfma_f32_32x32x16_bf16 v[112:127], v[244:247], v[52:55], v[112:127]
    s_waitcnt vmcnt(2)
    v_mfma_f32_32x32x16_bf16 v[64:79], v[248:251], v[56:59], v[64:79]
    v_mfma_f32_32x32x16_bf16 v[80:95], v[248:251], v[60:63], v[80:95]
    v_mfma_f32_32x32x16_bf16 v[96:111], v[252:255], v[56:59], v[96:111]
    v_mfma_f32_32x32x16_bf16 v[112:127], v[252:255], v[60:63], v[112:127]
    s_nop 8
    ds_write_b128 v11, v[64:67] offset:0
    ds_write_b128 v11, v[68:71] offset:1088
    ds_write_b128 v11, v[72:75] offset:17536
    ds_write_b128 v11, v[76:79] offset:18624
    ds_write_b128 v11, v[80:83] offset:35072
    ds_write_b128 v11, v[84:87] offset:36160
    ds_write_b128 v11, v[88:91] offset:52608
    ds_write_b128 v11, v[92:95] offset:53696
    ds_write_b128 v12, v[96:99] offset:0
    ds_write_b128 v12, v[100:103] offset:1088
    ds_write_b128 v12, v[104:107] offset:17536
    ds_write_b128 v12, v[108:111] offset:18624
    ds_write_b128 v12, v[112:115] offset:35072
    ds_write_b128 v12, v[116:119] offset:36160
    ds_write_b128 v12, v[120:123] offset:52608
    ds_write_b128 v12, v[124:127] offset:53696
    s_waitcnt vmcnt(0)
    ds_write_b128 v4, v[148:151]
    s_waitcnt lgkmcnt(0)
    s_barrier
    ds_read_u16 v152, v5 offset:0
    ds_read_u16 v153, v5 offset:128
    ds_read_u16 v154, v5 offset:256
    ds_read_u16 v155, v5 offset:384
    ds_read_u16 v156, v5 offset:512
    ds_read_u16 v157, v5 offset:640
    ds_read_u16 v158, v5 offset:768
    ds_read_u16 v159, v5 offset:896
    ds_read_b128 v[16:19], v13 offset:0
    ds_read_b128 v[20:23], v13 offset:512
    ds_read_b128 v[24:27], v13 offset:2176
    ds_read_b128 v[28:31], v13 offset:2688
    ds_read_b128 v[32:35], v13 offset:4352
    ds_read_b128 v[36:39], v13 offset:4864
    ds_read_b128 v[40:43], v13 offset:6528
    ds_read_b128 v[44:47], v13 offset:7040
    ds_read_b128 v[48:51], v13 offset:8704
    ds_read_b128 v[52:55], v13 offset:9216
    ds_read_b128 v[56:59], v13 offset:10880
    ds_read_b128 v[60:63], v13 offset:11392
    ds_read_b128 v[64:67], v13 offset:13056
    ds_read_b128 v[68:71], v13 offset:13568
    ds_read_b128 v[72:75], v13 offset:15232
    ds_read_b128 v[76:79], v13 offset:15744
    s_waitcnt lgkmcnt(12)
    v_add_f32 v16, v16, v24
    v_add_f32 v17, v17, v25
    v_add_f32 v18, v18, v26
    v_add_f32 v19, v19, v27
    v_add_f32 v20, v20, v28
    v_add_f32 v21, v21, v29
    v_add_f32 v22, v22, v30
    v_add_f32 v23, v23, v31
    s_waitcnt lgkmcnt(10)
    v_add_f32 v16, v16, v32
    v_add_f32 v17, v17, v33
    v_add_f32 v18, v18, v34
    v_add_f32 v19, v19, v35
    v_add_f32 v20, v20, v36
    v_add_f32 v21, v21, v37
    v_add_f32 v22, v22, v38
    v_add_f32 v23, v23, v39
    s_waitcnt lgkmcnt(8)
    v_add_f32 v16, v16, v40
    v_add_f32 v17, v17, v41
    v_add_f32 v18, v18, v42
    v_add_f32 v19, v19, v43
    v_add_f32 v20, v20, v44
    v_add_f32 v21, v21, v45
    v_add_f32 v22, v22, v46
    v_add_f32 v23, v23, v47
    s_waitcnt lgkmcnt(6)
    v_add_f32 v16, v16, v48
    v_add_f32 v17, v17, v49
    v_add_f32 v18, v18, v50
    v_add_f32 v19, v19, v51
    v_add_f32 v20, v20, v52
    v_add_f32 v21, v21, v53
    v_add_f32 v22, v22, v54
    v_add_f32 v23, v23, v55
    s_waitcnt lgkmcnt(4)
    v_add_f32 v16, v16, v56
    v_add_f32 v17, v17, v57
    v_add_f32 v18, v18, v58
    v_add_f32 v19, v19, v59
    v_add_f32 v20, v20, v60
    v_add_f32 v21, v21, v61
    v_add_f32 v22, v22, v62
    v_add_f32 v23, v23, v63
    s_waitcnt lgkmcnt(2)
    v_add_f32 v16, v16, v64
    v_add_f32 v17, v17, v65
    v_add_f32 v18, v18, v66
    v_add_f32 v19, v19, v67
    v_add_f32 v20, v20, v68
    v_add_f32 v21, v21, v69
    v_add_f32 v22, v22, v70
    v_add_f32 v23, v23, v71
    s_waitcnt lgkmcnt(0)
    v_add_f32 v16, v16, v72
    v_add_f32 v17, v17, v73
    v_add_f32 v18, v18, v74
    v_add_f32 v19, v19, v75
    v_add_f32 v20, v20, v76
    v_add_f32 v21, v21, v77
    v_add_f32 v22, v22, v78
    v_add_f32 v23, v23, v79
    v_lshlrev_b32 v160, 16, v144
    v_and_b32 v161, 0xffff0000, v144
    v_cvt_pk_bf16_f32 v114, v16, v17
    v_lshlrev_b32 v112, 16, v114
    v_and_b32 v113, 0xffff0000, v114
    v_mul_f32 v112, v112, v160
    v_mul_f32 v113, v113, v161
    v_cvt_pk_bf16_f32 v114, v112, v113
    v_lshlrev_b32 v112, 16, v114
    v_and_b32 v113, 0xffff0000, v114
    v_lshlrev_b32 v152, 16, v152
    v_lshlrev_b32 v153, 16, v153
    v_add_f32 v112, v112, v152
    v_add_f32 v113, v113, v153
    v_cvt_pk_bf16_f32 v120, v112, v113
    v_lshlrev_b32 v162, 16, v145
    v_and_b32 v163, 0xffff0000, v145
    v_cvt_pk_bf16_f32 v118, v18, v19
    v_lshlrev_b32 v116, 16, v118
    v_and_b32 v117, 0xffff0000, v118
    v_mul_f32 v116, v116, v162
    v_mul_f32 v117, v117, v163
    v_cvt_pk_bf16_f32 v118, v116, v117
    v_lshlrev_b32 v116, 16, v118
    v_and_b32 v117, 0xffff0000, v118
    v_lshlrev_b32 v154, 16, v154
    v_lshlrev_b32 v155, 16, v155
    v_add_f32 v116, v116, v154
    v_add_f32 v117, v117, v155
    v_cvt_pk_bf16_f32 v121, v116, v117
    v_lshlrev_b32 v164, 16, v146
    v_and_b32 v165, 0xffff0000, v146
    v_cvt_pk_bf16_f32 v114, v20, v21
    v_lshlrev_b32 v112, 16, v114
    v_and_b32 v113, 0xffff0000, v114
    v_mul_f32 v112, v112, v164
    v_mul_f32 v113, v113, v165
    v_cvt_pk_bf16_f32 v114, v112, v113
    v_lshlrev_b32 v112, 16, v114
    v_and_b32 v113, 0xffff0000, v114
    v_lshlrev_b32 v156, 16, v156
    v_lshlrev_b32 v157, 16, v157
    v_add_f32 v112, v112, v156
    v_add_f32 v113, v113, v157
    v_cvt_pk_bf16_f32 v122, v112, v113
    v_lshlrev_b32 v166, 16, v147
    v_and_b32 v167, 0xffff0000, v147
    v_cvt_pk_bf16_f32 v118, v22, v23
    v_lshlrev_b32 v116, 16, v118
    v_and_b32 v117, 0xffff0000, v118
    v_mul_f32 v116, v116, v166
    v_mul_f32 v117, v117, v167
    v_cvt_pk_bf16_f32 v118, v116, v117
    v_lshlrev_b32 v116, 16, v118
    v_and_b32 v117, 0xffff0000, v118
    v_lshlrev_b32 v158, 16, v158
    v_lshlrev_b32 v159, 16, v159
    v_add_f32 v116, v116, v158
    v_add_f32 v117, v117, v159
    v_cvt_pk_bf16_f32 v123, v116, v117
    global_store_dwordx4 v10, v[120:123], s[42:43] sc1
K_END:
    s_endpgm
.fill 2048, 4, 0xbf800000
PADEND:
.set PFCHUNK, 4096
.if (PADEND-PFBASE) < 8*4096
.error "prefetch range exceeds code"
.endif
.section .rodata,"a"
.p2align 6
.amdhsa_kernel adaLN_cond__ssm_conv_s4d__glu_gated_geglu__prompt_kernel
  .amdhsa_next_free_vgpr 256
  .amdhsa_next_free_sgpr 102
  .amdhsa_accum_offset 256
  .amdhsa_group_segment_fixed_size 0
  .amdhsa_kernarg_size 128
  .amdhsa_user_sgpr_count 2
  .amdhsa_user_sgpr_kernarg_segment_ptr 1
  .amdhsa_system_sgpr_workgroup_id_x 1
.end_amdhsa_kernel
```
